```python
import torch

def _softmax(x, axis=-1):
    return torch.softmax(x, dim=axis)
def _gelu(x):
    return torch.nn.functional.gelu(x, approximate="tanh")
def _silu(x):
    return torch.nn.functional.silu(x)
def _sigmoid(x):
    return torch.sigmoid(x)
def _layernorm(x, axis=-1, eps=1e-5):
    m = x.mean(dim=axis, keepdim=True)
    v = x.var(dim=axis, keepdim=True, unbiased=False)
    return (x - m) / torch.sqrt(v + eps)
def _scatter_add(tgt, idx, src, axis=0):
    return tgt.clone().index_add_(axis, idx, src)
def _segment_sum(src, seg, n):
    out = torch.zeros((n,) + src.shape[1:], dtype=src.dtype)
    return out.index_add_(0, seg, src)
def _pad(x, pw):
    flat = tuple(v for pair in reversed(pw) for v in pair)
    return torch.nn.functional.pad(x, flat)

kernel_name = 'concat_heads__compressed_kv_cla__sliding_block_cached__decode'

def setup_inputs():

    _w = (lambda a: (lambda t: t.to(torch.bfloat16) if t.is_floating_point() else t)(torch.as_tensor(a)))
    def _A_setup():
        B, H, Sq, Sk, D, M = 1, 32, 1, 8192, 128, 576
        Dc = 4 * D
        return {
            "x": _w((lambda *s: torch.randn(*s, dtype=torch.bfloat16) * 3.2)(B, Sq, M)),
            "c_kv": _w((lambda *s: torch.randn(*s, dtype=torch.bfloat16) * 0.1)(B, Sk, Dc)),
            "w_q": _w((lambda *s: torch.randn(*s, dtype=torch.bfloat16) * 6.4)(M, H, D) * (M ** -0.5)),
            "w_uk": _w((lambda *s: torch.randn(*s, dtype=torch.bfloat16) * 6.4)(Dc, H, D) * (Dc ** -0.5)),
            "w_uv": _w((lambda *s: torch.randn(*s, dtype=torch.bfloat16) * 0.1)(Dc, H, D) * (Dc ** -0.5)),
            "w_o": _w((lambda *s: torch.randn(*s, dtype=torch.bfloat16) * 0.1)(H, D, M) * ((H * D) ** -0.5)),
        }
    _A_in = _A_setup()

    def _B_setup():
        B, Sq, D = 1, 1, 576
        Hq, Hkv, Sk, Dh = 32, 16, 8192, 128
        assert Hq % Hkv == 0, (Hq, Hkv)
        return {
            "x": _w((lambda *s: torch.randn(*s, dtype=torch.bfloat16) * 1.6)(B, Sq, D)),
            "k_cache": _w((lambda *s: torch.randn(*s, dtype=torch.bfloat16) * 1.6)(B, Hkv, Sk, Dh)),
            "v_cache": _w((lambda *s: torch.randn(*s, dtype=torch.bfloat16) * 0.05)(B, Hkv, Sk, Dh)),
            "wq": _w((lambda *s: torch.randn(*s, dtype=torch.bfloat16) * 1.6)(D, Hq * Dh) * (D ** -0.5)),
            "wo": _w((lambda *s: torch.randn(*s, dtype=torch.bfloat16) * 0.05)(Hq * Dh, D) * ((Hq * Dh) ** -0.5)),
        }
    _B_in = _B_setup()

    return {
        "A_x": _A_in["x"],
        "A_c_kv": _A_in["c_kv"],
        "A_w_q": _A_in["w_q"],
        "A_w_uk": _A_in["w_uk"],
        "A_w_uv": _A_in["w_uv"],
        "A_w_o": _A_in["w_o"],
        "B_x": _B_in["x"],
        "B_k_cache": _B_in["k_cache"],
        "B_v_cache": _B_in["v_cache"],
        "B_wq": _B_in["wq"],
        "B_wo": _B_in["wo"],
    }

def reference(A_x, A_c_kv, A_w_q, A_w_uk, A_w_uv, A_w_o, B_x, B_k_cache, B_v_cache, B_wq, B_wo):
    def _A_ref(x, c_kv, w_q, w_uk, w_uv, w_o):
        B, Sq, M = x.shape[0], x.shape[1], x.shape[2]
        Sk = c_kv.shape[1]
        H, D = w_q.shape[1], w_q.shape[2]
        q = torch.einsum("bqm,mhd->bhqd", x, w_q)
        k = torch.einsum("bkc,chd->bhkd", c_kv, w_uk)
        v = torch.einsum("bkc,chd->bhkd", c_kv, w_uv)
        scores = torch.einsum("bhqd,bhkd->bhqk", q, k) * (D ** -0.5)
        off = Sk - Sq
        qi = torch.arange(Sq)[:, None]
        kj = torch.arange(Sk)[None, :]
        cmask = kj <= (qi + off)
        scores = torch.where(cmask[None, None], scores, -1e9)
        p = _softmax(scores, axis=-1)
        ctx = torch.einsum("bhqk,bhkd->bhqd", p, v)
        return torch.einsum("bhqd,hdm->bqm", ctx, w_o)

    def _B_ref(x, k_cache, v_cache, wq, wo):
        B, Sq, D = x.shape
        Hq, Dh = 32, 128
        Hkv, Sk = k_cache.shape[1], k_cache.shape[2]
        W = min(4096, max(256, Sk // 4))
        rep = Hq // Hkv
        q = (lambda x, *d: x.permute(*d))((x @ wq).reshape(B, Sq, Hq, Dh), 0, 2, 1, 3)
        k = (lambda x, n, axis: torch.repeat_interleave(x, n, dim=axis))(k_cache[:, :, Sk - W:, :], rep, axis=1)
        v = (lambda x, n, axis: torch.repeat_interleave(x, n, dim=axis))(v_cache[:, :, Sk - W:, :], rep, axis=1)
        scores = torch.einsum("bhqd,bhkd->bhqk", q, k) * (Dh ** -0.5)
        p = _softmax(scores, axis=-1)
        o = torch.einsum("bhqk,bhkd->bhqd", p, v)
        return (lambda x, *d: x.permute(*d))(o, 0, 2, 1, 3).reshape(B, Sq, Hq * Dh) @ wo

    a = _A_ref(A_x, A_c_kv, A_w_q, A_w_uk, A_w_uv, A_w_o)
    b = _B_ref(B_x, B_k_cache, B_v_cache, B_wq, B_wo)
    return torch.concatenate([a, b], axis=-1)
```

```asm
; @launch grid=(256,1,1) block=(512,1,1) lds=163840
.amdgcn_target "amdgcn-amd-amdhsa--gfx950"
.text
.globl concat_heads__compressed_kv_cla__sliding_block_cached__decode_kernel
.p2align 8
.type concat_heads__compressed_kv_cla__sliding_block_cached__decode_kernel,@function
concat_heads__compressed_kv_cla__sliding_block_cached__decode_kernel:
    s_cmp_ge_u32 s2, 256
    s_cbranch_scc1 L_exit0
    s_load_dwordx16 s[16:31], s[0:1], 0
    s_load_dwordx8 s[32:39], s[0:1], 64
    s_load_dwordx4 s[40:43], s[0:1], 96
    v_lshrrev_b32 v4, 6, v0
    v_and_b32 v1, 63, v0
    v_and_b32 v2, 15, v0
    v_readfirstlane_b32 s3, v4
    v_lshrrev_b32 v3, 4, v1
    s_and_b32 s86, s2, 127
    s_and_b32 s4, s2, 7
    s_lshr_b32 s5, s86, 3
    s_and_b32 s80, s5, 3
    s_lshr_b32 s6, s5, 2
    s_lshl_b32 s81, s6, 3
    s_add_u32 s81, s81, s4
    s_lshl_b32 s90, s4, 4
    s_and_b32 s7, s2, 128
    s_add_u32 s90, s90, s7
    s_getreg_b32 s100, hwreg(HW_REG_XCC_ID, 0, 4)
    s_add_u32 s100, s100, 1
    s_mul_i32 s100, s100, 0x01010101
    s_mov_b32 s101, s100
    v_mov_b32 v10, 0xff
    v_mov_b32 v11, 0x10001
    v_mov_b32 v253, 0x07060302
    s_mov_b32 s88, 0x3e0293ee
    s_mov_b32 s46, 9437184
    s_mov_b32 s47, 0x20000
    s_mov_b32 s58, 4718592
    s_mov_b32 s59, 0x20000
    s_mov_b32 s63, 0x20000
    s_mov_b32 s70, 4194304
    s_mov_b32 s71, 0x20000
    s_cmp_lt_u32 s2, 128
    s_cbranch_scc1 L_P
    s_lshr_b32 s83, s5, 1
    s_lshl_b32 s83, s83, 3
    s_add_u32 s83, s83, s4
    s_and_b32 s84, s5, 1
    s_mov_b32 s62, 8388608
    s_cmp_eq_u32 s3, 0
    s_cbranch_scc0 L_Sidle
    v_lshlrev_b32 v40, 4, v1
    v_xor_b32 v41, 16, v40
    v_xor_b32 v42, 32, v40
    v_xor_b32 v43, 48, v40
    v_xor_b32 v44, 64, v40
    v_xor_b32 v45, 80, v40
    v_xor_b32 v46, 96, v40
    v_xor_b32 v47, 112, v40
    v_xor_b32 v48, 128, v40
    v_xor_b32 v49, 144, v40
    v_xor_b32 v50, 160, v40
    v_xor_b32 v51, 176, v40
    v_xor_b32 v52, 192, v40
    v_xor_b32 v53, 208, v40
    v_xor_b32 v54, 224, v40
    v_xor_b32 v55, 240, v40
    s_lshl_b32 s8, s83, 17
    s_mov_b32 s9, 0
    s_waitcnt lgkmcnt(0)
    s_mov_b64 s[44:45], s[42:43]
    s_mov_b64 s[60:61], s[18:19]
    s_lshr_b32 s4, s86, 3
    s_add_u32 s4, s4, s90
    v_mov_b32 v5, s4
    v_mov_b32 v6, s100
    global_store_byte v5, v6, s[40:41]
    global_load_ubyte v254, v5, s[40:41] sc1
    s_mov_b32 m0, s9
    s_add_u32 s11, s9, s8
    s_add_u32 s9, s9, 4096
    buffer_load_dwordx4 v40, s[60:63], s11 offen offset:0 nt lds
    s_waitcnt vmcnt(15)
    buffer_load_dwordx4 v41, s[60:63], s11 offen offset:1024 nt lds
    s_waitcnt vmcnt(15)
    buffer_load_dwordx4 v42, s[60:63], s11 offen offset:2048 nt lds
    s_waitcnt vmcnt(15)
    buffer_load_dwordx4 v43, s[60:63], s11 offen offset:3072 nt lds
    s_waitcnt vmcnt(15)
    s_mov_b32 m0, s9
    s_add_u32 s11, s9, s8
    s_add_u32 s9, s9, 4096
    buffer_load_dwordx4 v44, s[60:63], s11 offen offset:0 nt lds
    s_waitcnt vmcnt(15)
    buffer_load_dwordx4 v45, s[60:63], s11 offen offset:1024 nt lds
    s_waitcnt vmcnt(15)
    buffer_load_dwordx4 v46, s[60:63], s11 offen offset:2048 nt lds
    s_waitcnt vmcnt(15)
    buffer_load_dwordx4 v47, s[60:63], s11 offen offset:3072 nt lds
    s_waitcnt vmcnt(15)
    s_mov_b32 m0, s9
    s_add_u32 s11, s9, s8
    s_add_u32 s9, s9, 4096
    buffer_load_dwordx4 v48, s[60:63], s11 offen offset:0 nt lds
    s_waitcnt vmcnt(15)
    buffer_load_dwordx4 v49, s[60:63], s11 offen offset:1024 nt lds
    s_waitcnt vmcnt(15)
    buffer_load_dwordx4 v50, s[60:63], s11 offen offset:2048 nt lds
    s_waitcnt vmcnt(15)
    buffer_load_dwordx4 v51, s[60:63], s11 offen offset:3072 nt lds
    s_waitcnt vmcnt(15)
    s_mov_b32 m0, s9
    s_add_u32 s11, s9, s8
    s_add_u32 s9, s9, 4096
    buffer_load_dwordx4 v52, s[60:63], s11 offen offset:0 nt lds
    s_waitcnt vmcnt(15)
    buffer_load_dwordx4 v53, s[60:63], s11 offen offset:1024 nt lds
    s_waitcnt vmcnt(15)
    buffer_load_dwordx4 v54, s[60:63], s11 offen offset:2048 nt lds
    s_waitcnt vmcnt(15)
    buffer_load_dwordx4 v55, s[60:63], s11 offen offset:3072 nt lds
    s_waitcnt vmcnt(15)
    s_load_dwordx2 s[76:77], s[42:43], 0
    s_mov_b64 s[68:69], s[24:25]
    s_mov_b64 s[56:57], s[26:27]
    s_call_b64 s[16:17], L_aaddr
    s_waitcnt lgkmcnt(0)
    s_add_u32 s76, s76, 1
    s_and_b32 s12, s76, 2
    s_lshl_b32 s12, s12, 15
    s_and_b32 s78, s76, 1
    s_or_b32 s78, s78, s12
    s_add_u32 s77, s77, 1
    s_and_b32 s12, s77, 2
    s_lshl_b32 s12, s12, 15
    s_and_b32 s79, s77, 1
    s_or_b32 s79, s79, s12
Lla_1:
    s_mov_b32 m0, s9
    s_add_u32 s11, s9, s8
    s_add_u32 s9, s9, 4096
    buffer_load_dwordx4 v40, s[60:63], s11 offen offset:0 nt lds
    s_waitcnt vmcnt(15)
    buffer_load_dwordx4 v41, s[60:63], s11 offen offset:1024 nt lds
    s_waitcnt vmcnt(15)
    buffer_load_dwordx4 v42, s[60:63], s11 offen offset:2048 nt lds
    s_waitcnt vmcnt(15)
    buffer_load_dwordx4 v43, s[60:63], s11 offen offset:3072 nt lds
    s_waitcnt vmcnt(15)
    s_mov_b32 m0, s9
    s_add_u32 s11, s9, s8
    s_add_u32 s9, s9, 4096
    buffer_load_dwordx4 v44, s[60:63], s11 offen offset:0 nt lds
    s_waitcnt vmcnt(15)
    buffer_load_dwordx4 v45, s[60:63], s11 offen offset:1024 nt lds
    s_waitcnt vmcnt(15)
    buffer_load_dwordx4 v46, s[60:63], s11 offen offset:2048 nt lds
    s_waitcnt vmcnt(15)
    buffer_load_dwordx4 v47, s[60:63], s11 offen offset:3072 nt lds
    s_waitcnt vmcnt(15)
    s_mov_b32 m0, s9
    s_add_u32 s11, s9, s8
    s_add_u32 s9, s9, 4096
    buffer_load_dwordx4 v48, s[60:63], s11 offen offset:0 nt lds
    s_waitcnt vmcnt(15)
    buffer_load_dwordx4 v49, s[60:63], s11 offen offset:1024 nt lds
    s_waitcnt vmcnt(15)
    buffer_load_dwordx4 v50, s[60:63], s11 offen offset:2048 nt lds
    s_waitcnt vmcnt(15)
    buffer_load_dwordx4 v51, s[60:63], s11 offen offset:3072 nt lds
    s_waitcnt vmcnt(15)
    s_mov_b32 m0, s9
    s_add_u32 s11, s9, s8
    s_add_u32 s9, s9, 4096
    buffer_load_dwordx4 v52, s[60:63], s11 offen offset:0 nt lds
    s_waitcnt vmcnt(15)
    buffer_load_dwordx4 v53, s[60:63], s11 offen offset:1024 nt lds
    s_waitcnt vmcnt(15)
    buffer_load_dwordx4 v54, s[60:63], s11 offen offset:2048 nt lds
    s_waitcnt vmcnt(15)
    buffer_load_dwordx4 v55, s[60:63], s11 offen offset:3072 nt lds
    s_waitcnt vmcnt(15)
    s_cmp_lt_u32 s9, 32768
    s_cbranch_scc1 Lla_1
Lla_2:
    s_mov_b32 m0, s9
    s_add_u32 s11, s9, s8
    s_add_u32 s9, s9, 4096
    buffer_load_dwordx4 v40, s[60:63], s11 offen offset:0 nt lds
    s_waitcnt vmcnt(31)
    buffer_load_dwordx4 v41, s[60:63], s11 offen offset:1024 nt lds
    s_waitcnt vmcnt(31)
    buffer_load_dwordx4 v42, s[60:63], s11 offen offset:2048 nt lds
    s_waitcnt vmcnt(31)
    buffer_load_dwordx4 v43, s[60:63], s11 offen offset:3072 nt lds
    s_waitcnt vmcnt(31)
    s_mov_b32 m0, s9
    s_add_u32 s11, s9, s8
    s_add_u32 s9, s9, 4096
    buffer_load_dwordx4 v44, s[60:63], s11 offen offset:0 nt lds
    s_waitcnt vmcnt(31)
    buffer_load_dwordx4 v45, s[60:63], s11 offen offset:1024 nt lds
    s_waitcnt vmcnt(31)
    buffer_load_dwordx4 v46, s[60:63], s11 offen offset:2048 nt lds
    s_waitcnt vmcnt(31)
    buffer_load_dwordx4 v47, s[60:63], s11 offen offset:3072 nt lds
    s_waitcnt vmcnt(31)
    s_mov_b32 m0, s9
    s_add_u32 s11, s9, s8
    s_add_u32 s9, s9, 4096
    buffer_load_dwordx4 v48, s[60:63], s11 offen offset:0 nt lds
    s_waitcnt vmcnt(31)
    buffer_load_dwordx4 v49, s[60:63], s11 offen offset:1024 nt lds
    s_waitcnt vmcnt(31)
    buffer_load_dwordx4 v50, s[60:63], s11 offen offset:2048 nt lds
    s_waitcnt vmcnt(31)
    buffer_load_dwordx4 v51, s[60:63], s11 offen offset:3072 nt lds
    s_waitcnt vmcnt(31)
    s_mov_b32 m0, s9
    s_add_u32 s11, s9, s8
    s_add_u32 s9, s9, 4096
    buffer_load_dwordx4 v52, s[60:63], s11 offen offset:0 nt lds
    s_waitcnt vmcnt(31)
    buffer_load_dwordx4 v53, s[60:63], s11 offen offset:1024 nt lds
    s_waitcnt vmcnt(31)
    buffer_load_dwordx4 v54, s[60:63], s11 offen offset:2048 nt lds
    s_waitcnt vmcnt(31)
    buffer_load_dwordx4 v55, s[60:63], s11 offen offset:3072 nt lds
    s_waitcnt vmcnt(31)
    s_cmp_lt_u32 s9, 131072
    s_cbranch_scc1 Lla_2
    s_branch L_A2
L_P:
    s_lshr_b32 s83, s5, 3
    s_lshl_b32 s83, s83, 3
    s_add_u32 s83, s83, s4
    s_and_b32 s6, s6, 1
    s_lshl_b32 s82, s83, 1
    s_add_u32 s82, s82, s6
    s_and_b32 s84, s5, 7
    s_mov_b32 s50, 1152
    s_mov_b32 s51, 0x20000
    s_mov_b32 s54, 4718592
    s_mov_b32 s55, 0x20000
    s_cmp_eq_u32 s3, 0
    s_cbranch_scc1 L_Pload
    s_cmp_gt_u32 s3, 2
    s_cbranch_scc1 L_Pidle
    s_sub_u32 s8, s3, 1
    v_lshrrev_b32 v4, 3, v1
    v_mul_u32_u24 v22, 36, v4
    v_mul_u32_u24 v21, 147456, v4
    v_and_b32 v4, 7, v1
    v_lshl_add_u32 v21, v4, 4, v21
    s_mul_i32 s12, s80, 288
    s_mul_i32 s13, s80, 1179648
    s_lshl_b32 s4, s81, 8
    s_add_u32 s13, s13, s4
    s_lshl_b32 s4, s8, 7
    s_add_u32 s13, s13, s4
    v_lshlrev_b32 v23, 4, v1
    s_lshl_b32 s9, s81, 12
    s_lshl_b32 s5, s8, 11
    s_add_u32 s9, s9, s5
    s_add_u32 s9, s9, 6291456
    s_waitcnt lgkmcnt(0)
    s_mov_b64 s[44:45], s[42:43]
    s_lshr_b32 s4, s86, 3
    s_add_u32 s4, s4, s90
    v_mov_b32 v5, s4
    v_mov_b32 v6, s100
    global_store_byte v5, v6, s[40:41]
    global_load_ubyte v254, v5, s[40:41] sc1
    s_mov_b64 s[48:49], s[16:17]
    s_mov_b64 s[52:53], s[20:21]
    buffer_load_dwordx4 v[112:115], v23, s[44:47], s9 offen sc1
    buffer_load_dwordx4 v[116:119], v23, s[44:47], s9 offen offset:1024 sc1
    buffer_load_dwordx4 v[12:15], v22, s[48:51], s12 offen
    buffer_load_dwordx4 v[16:19], v22, s[48:51], s12 offen offset:16
    buffer_load_dword v20, v22, s[48:51], s12 offen offset:32
    buffer_load_dwordx4 v[40:43], v21, s[52:55], s13 offen nt
    s_add_u32 s13, s13, 8192
    buffer_load_dwordx4 v[44:47], v21, s[52:55], s13 offen nt
    s_add_u32 s13, s13, 8192
    buffer_load_dwordx4 v[48:51], v21, s[52:55], s13 offen nt
    s_add_u32 s13, s13, 8192
    buffer_load_dwordx4 v[52:55], v21, s[52:55], s13 offen nt
    s_add_u32 s13, s13, 8192
    buffer_load_dwordx4 v[56:59], v21, s[52:55], s13 offen nt
    s_add_u32 s13, s13, 8192
    buffer_load_dwordx4 v[60:63], v21, s[52:55], s13 offen nt
    s_add_u32 s13, s13, 8192
    buffer_load_dwordx4 v[64:67], v21, s[52:55], s13 offen nt
    s_add_u32 s13, s13, 8192
    buffer_load_dwordx4 v[68:71], v21, s[52:55], s13 offen nt
    s_add_u32 s13, s13, 8192
    buffer_load_dwordx4 v[72:75], v21, s[52:55], s13 offen nt
    s_add_u32 s13, s13, 8192
    buffer_load_dwordx4 v[76:79], v21, s[52:55], s13 offen nt
    s_add_u32 s13, s13, 8192
    buffer_load_dwordx4 v[80:83], v21, s[52:55], s13 offen nt
    s_add_u32 s13, s13, 8192
    buffer_load_dwordx4 v[84:87], v21, s[52:55], s13 offen nt
    s_add_u32 s13, s13, 8192
    buffer_load_dwordx4 v[88:91], v21, s[52:55], s13 offen nt
    s_add_u32 s13, s13, 8192
    buffer_load_dwordx4 v[92:95], v21, s[52:55], s13 offen nt
    s_add_u32 s13, s13, 8192
    buffer_load_dwordx4 v[96:99], v21, s[52:55], s13 offen nt
    s_add_u32 s13, s13, 8192
    buffer_load_dwordx4 v[100:103], v21, s[52:55], s13 offen nt
    s_add_u32 s13, s13, 8192
    buffer_load_dwordx4 v[104:107], v21, s[52:55], s13 offen nt
    s_add_u32 s13, s13, 8192
    buffer_load_dwordx4 v[108:111], v21, s[52:55], s13 offen nt
    s_load_dwordx2 s[76:77], s[42:43], 0
    s_barrier
    s_mov_b32 s13, s9
    v_and_b32 v4, 7, v1
    v_lshlrev_b32 v4, 5, v4
    v_lshl_add_u32 v9, v3, 3, v4
    v_bfe_u32 v4, v1, 3, 1
    v_lshl_add_u32 v9, v4, 11, v9
    s_lshl_b32 s26, s81, 12
    s_lshl_b32 s5, s80, 9
    s_add_u32 s26, s26, s5
    s_lshl_b32 s5, s8, 8
    s_add_u32 s26, s26, s5
    s_add_u32 s26, s26, 6291456
    s_lshl_b32 s4, s8, 14
    s_add_u32 s4, s4, 65536
    v_and_b32 v4, 31, v1
    v_lshrrev_b32 v5, 5, v1
    v_lshlrev_b32 v6, 4, v4
    v_lshl_add_u32 v22, v5, 9, v6
    v_lshlrev_b32 v5, 2, v5
    v_lshl_add_u32 v185, v4, 3, v5
    v_xor_b32 v4, v3, v2
    v_lshlrev_b32 v4, 4, v4
    v_lshl_add_u32 v186, v2, 8, v4
    v_add_u32 v180, s4, v186
    v_xor_b32 v181, 64, v180
    v_xor_b32 v182, 0x80, v180
    v_xor_b32 v183, 0xc0, v180
    s_lshl_b32 s9, s8, 8
    s_add_u32 s9, s9, 131072
    v_add_u32 v21, s9, v185
    v_lshl_add_u32 v23, v3, 4, s9
    v_mov_b32 v184, 135168
    v_mov_b32 v187, 1
    v_and_b32 v6, 3, v2
    v_lshlrev_b32 v5, 5, v6
    v_lshl_add_u32 v188, v3, 3, v5
    v_cmp_eq_u32 s[72:73], 1, v6
    v_cmp_eq_u32 s[6:7], 2, v6
    v_cmp_eq_u32 s[10:11], 3, v6
    s_lshl_b32 s9, s81, 10
    s_lshl_b32 s5, s80, 8
    s_add_u32 s9, s9, s5
    s_lshl_b32 s5, s8, 7
    s_add_u32 s9, s9, s5
    s_add_u32 s9, s9, 7340032
    s_waitcnt lgkmcnt(0)
    s_add_u32 s76, s76, 1
    s_and_b32 s12, s76, 2
    s_lshl_b32 s12, s12, 15
    s_and_b32 s78, s76, 1
    s_or_b32 s78, s78, s12
    s_add_u32 s77, s77, 1
    s_and_b32 s12, s77, 2
    s_lshl_b32 s12, s12, 15
    s_and_b32 s79, s77, 1
    s_or_b32 s79, s79, s12
    s_mov_b32 s27, s76
    s_call_b64 s[24:25], L_s1
    s_branch L_Pw2
L_s1:
    s_mov_b32 s18, 0x05040100
    s_mov_b32 s19, 0x07060302
    v_mov_b32 v24, 0
    v_mov_b32 v25, 0
    v_mov_b32 v26, 0
    v_mov_b32 v27, 0
    v_mov_b32 v28, 0
    v_mov_b32 v29, 0
    v_mov_b32 v30, 0
    v_mov_b32 v31, 0
    s_waitcnt vmcnt(16)
    v_perm_b32 v32, v44, v40, s18
    v_perm_b32 v33, v44, v40, s19
    v_perm_b32 v34, v45, v41, s18
    v_perm_b32 v35, v45, v41, s19
    v_perm_b32 v36, v46, v42, s18
    v_perm_b32 v37, v46, v42, s19
    v_perm_b32 v38, v47, v43, s18
    v_perm_b32 v39, v47, v43, s19
    v_dot2c_f32_bf16 v24, v32, v12
    v_dot2c_f32_bf16 v25, v33, v12
    v_dot2c_f32_bf16 v26, v34, v12
    v_dot2c_f32_bf16 v27, v35, v12
    v_dot2c_f32_bf16 v28, v36, v12
    v_dot2c_f32_bf16 v29, v37, v12
    v_dot2c_f32_bf16 v30, v38, v12
    v_dot2c_f32_bf16 v31, v39, v12
    s_waitcnt vmcnt(14)
    v_perm_b32 v32, v52, v48, s18
    v_perm_b32 v33, v52, v48, s19
    v_perm_b32 v34, v53, v49, s18
    v_perm_b32 v35, v53, v49, s19
    v_perm_b32 v36, v54, v50, s18
    v_perm_b32 v37, v54, v50, s19
    v_perm_b32 v38, v55, v51, s18
    v_perm_b32 v39, v55, v51, s19
    v_dot2c_f32_bf16 v24, v32, v13
    v_dot2c_f32_bf16 v25, v33, v13
    v_dot2c_f32_bf16 v26, v34, v13
    v_dot2c_f32_bf16 v27, v35, v13
    v_dot2c_f32_bf16 v28, v36, v13
    v_dot2c_f32_bf16 v29, v37, v13
    v_dot2c_f32_bf16 v30, v38, v13
    v_dot2c_f32_bf16 v31, v39, v13
    s_waitcnt vmcnt(12)
    v_perm_b32 v32, v60, v56, s18
    v_perm_b32 v33, v60, v56, s19
    v_perm_b32 v34, v61, v57, s18
    v_perm_b32 v35, v61, v57, s19
    v_perm_b32 v36, v62, v58, s18
    v_perm_b32 v37, v62, v58, s19
    v_perm_b32 v38, v63, v59, s18
    v_perm_b32 v39, v63, v59, s19
    v_dot2c_f32_bf16 v24, v32, v14
    v_dot2c_f32_bf16 v25, v33, v14
    v_dot2c_f32_bf16 v26, v34, v14
    v_dot2c_f32_bf16 v27, v35, v14
    v_dot2c_f32_bf16 v28, v36, v14
    v_dot2c_f32_bf16 v29, v37, v14
    v_dot2c_f32_bf16 v30, v38, v14
    v_dot2c_f32_bf16 v31, v39, v14
    s_waitcnt vmcnt(10)
    v_perm_b32 v32, v68, v64, s18
    v_perm_b32 v33, v68, v64, s19
    v_perm_b32 v34, v69, v65, s18
    v_perm_b32 v35, v69, v65, s19
    v_perm_b32 v36, v70, v66, s18
    v_perm_b32 v37, v70, v66, s19
    v_perm_b32 v38, v71, v67, s18
    v_perm_b32 v39, v71, v67, s19
    v_dot2c_f32_bf16 v24, v32, v15
    v_dot2c_f32_bf16 v25, v33, v15
    v_dot2c_f32_bf16 v26, v34, v15
    v_dot2c_f32_bf16 v27, v35, v15
    v_dot2c_f32_bf16 v28, v36, v15
    v_dot2c_f32_bf16 v29, v37, v15
    v_dot2c_f32_bf16 v30, v38, v15
    v_dot2c_f32_bf16 v31, v39, v15
    s_waitcnt vmcnt(8)
    v_perm_b32 v32, v76, v72, s18
    v_perm_b32 v33, v76, v72, s19
    v_perm_b32 v34, v77, v73, s18
    v_perm_b32 v35, v77, v73, s19
    v_perm_b32 v36, v78, v74, s18
    v_perm_b32 v37, v78, v74, s19
    v_perm_b32 v38, v79, v75, s18
    v_perm_b32 v39, v79, v75, s19
    v_dot2c_f32_bf16 v24, v32, v16
    v_dot2c_f32_bf16 v25, v33, v16
    v_dot2c_f32_bf16 v26, v34, v16
    v_dot2c_f32_bf16 v27, v35, v16
    v_dot2c_f32_bf16 v28, v36, v16
    v_dot2c_f32_bf16 v29, v37, v16
    v_dot2c_f32_bf16 v30, v38, v16
    v_dot2c_f32_bf16 v31, v39, v16
    s_waitcnt vmcnt(6)
    s_load_dwordx4 s[92:95], s[40:41], s90
    v_perm_b32 v32, v84, v80, s18
    v_perm_b32 v33, v84, v80, s19
    v_perm_b32 v34, v85, v81, s18
    v_perm_b32 v35, v85, v81, s19
    v_perm_b32 v36, v86, v82, s18
    v_perm_b32 v37, v86, v82, s19
    v_perm_b32 v38, v87, v83, s18
    v_perm_b32 v39, v87, v83, s19
    v_dot2c_f32_bf16 v24, v32, v17
    v_dot2c_f32_bf16 v25, v33, v17
    v_dot2c_f32_bf16 v26, v34, v17
    v_dot2c_f32_bf16 v27, v35, v17
    v_dot2c_f32_bf16 v28, v36, v17
    v_dot2c_f32_bf16 v29, v37, v17
    v_dot2c_f32_bf16 v30, v38, v17
    v_dot2c_f32_bf16 v31, v39, v17
    s_waitcnt vmcnt(4)
    v_perm_b32 v32, v92, v88, s18
    v_perm_b32 v33, v92, v88, s19
    v_perm_b32 v34, v93, v89, s18
    v_perm_b32 v35, v93, v89, s19
    v_perm_b32 v36, v94, v90, s18
    v_perm_b32 v37, v94, v90, s19
    v_perm_b32 v38, v95, v91, s18
    v_perm_b32 v39, v95, v91, s19
    v_dot2c_f32_bf16 v24, v32, v18
    v_dot2c_f32_bf16 v25, v33, v18
    v_dot2c_f32_bf16 v26, v34, v18
    v_dot2c_f32_bf16 v27, v35, v18
    v_dot2c_f32_bf16 v28, v36, v18
    v_dot2c_f32_bf16 v29, v37, v18
    v_dot2c_f32_bf16 v30, v38, v18
    v_dot2c_f32_bf16 v31, v39, v18
    s_waitcnt vmcnt(2)
    v_perm_b32 v32, v100, v96, s18
    v_perm_b32 v33, v100, v96, s19
    v_perm_b32 v34, v101, v97, s18
    v_perm_b32 v35, v101, v97, s19
    v_perm_b32 v36, v102, v98, s18
    v_perm_b32 v37, v102, v98, s19
    v_perm_b32 v38, v103, v99, s18
    v_perm_b32 v39, v103, v99, s19
    v_dot2c_f32_bf16 v24, v32, v19
    v_dot2c_f32_bf16 v25, v33, v19
    v_dot2c_f32_bf16 v26, v34, v19
    v_dot2c_f32_bf16 v27, v35, v19
    v_dot2c_f32_bf16 v28, v36, v19
    v_dot2c_f32_bf16 v29, v37, v19
    v_dot2c_f32_bf16 v30, v38, v19
    v_dot2c_f32_bf16 v31, v39, v19
    s_waitcnt vmcnt(0)
    s_waitcnt lgkmcnt(0)
    s_mov_b32 s85, 1
    s_cmp_eq_u64 s[92:93], s[100:101]
    s_cselect_b32 s85, s85, 0
    s_cmp_eq_u64 s[94:95], s[100:101]
    s_cselect_b32 s85, s85, 0
    v_perm_b32 v32, v108, v104, s18
    v_perm_b32 v33, v108, v104, s19
    v_perm_b32 v34, v109, v105, s18
    v_perm_b32 v35, v109, v105, s19
    v_perm_b32 v36, v110, v106, s18
    v_perm_b32 v37, v110, v106, s19
    v_perm_b32 v38, v111, v107, s18
    v_perm_b32 v39, v111, v107, s19
    v_dot2c_f32_bf16 v24, v32, v20
    v_dot2c_f32_bf16 v25, v33, v20
    v_dot2c_f32_bf16 v26, v34, v20
    v_dot2c_f32_bf16 v27, v35, v20
    v_dot2c_f32_bf16 v28, v36, v20
    v_dot2c_f32_bf16 v29, v37, v20
    v_dot2c_f32_bf16 v30, v38, v20
    v_dot2c_f32_bf16 v31, v39, v20
    v_permlane32_swap_b32 v24, v28
    v_permlane32_swap_b32 v25, v29
    v_permlane32_swap_b32 v26, v30
    v_permlane32_swap_b32 v27, v31
    v_add_f32 v24, v24, v28
    v_add_f32 v25, v25, v29
    v_add_f32 v26, v26, v30
    v_add_f32 v27, v27, v31
    s_nop 0
    v_permlane16_swap_b32 v24, v26
    v_permlane16_swap_b32 v25, v27
    v_add_f32 v24, v24, v26
    v_add_f32 v25, v25, v27
    s_nop 0
    v_add_f32_dpp v24, v24, v24 row_ror:8 row_mask:0xf bank_mask:0xf
    v_add_f32_dpp v25, v25, v25 row_ror:8 row_mask:0xf bank_mask:0xf
    v_bfi_b32 v24, v10, s27, v24
    v_bfi_b32 v25, v10, s27, v25
    s_cmp_eq_u32 s85, 1
    s_cbranch_scc1 Ls_3
    buffer_store_dwordx2 v[24:25], v9, s[44:47], s26 offen sc1
    s_branch Ls_4
Ls_3:
    buffer_store_dwordx2 v[24:25], v9, s[44:47], s26 offen
Ls_4:
    s_setpc_b64 s[24:25]
L_Pw2:
    s_mov_b32 s87, 1048576
Lf_5:
    ds_read_b32 v4, v184
    s_waitcnt lgkmcnt(0)
    v_cmp_gt_u32 vcc, 1, v4
    s_cbranch_vccz Lg_6
    s_sub_u32 s87, s87, 1
    s_cbranch_scc0 Lf_5
Lg_6:
    buffer_load_dwordx4 v[40:43], v22, s[44:47], s13 offen sc1
    buffer_load_dwordx4 v[44:47], v22, s[44:47], s13 offen offset:1024 sc1
    ds_read_b128 v[116:119], v180 offset:0
    ds_read_b128 v[132:135], v180 offset:4096
    ds_read_b128 v[148:151], v180 offset:8192
    ds_read_b128 v[164:167], v180 offset:12288
    ds_read_b128 v[120:123], v181 offset:0
    ds_read_b128 v[136:139], v181 offset:4096
    ds_read_b128 v[152:155], v181 offset:8192
    ds_read_b128 v[168:171], v181 offset:12288
    ds_read_b128 v[124:127], v182 offset:0
    ds_read_b128 v[140:143], v182 offset:4096
    ds_read_b128 v[156:159], v182 offset:8192
    ds_read_b128 v[172:175], v182 offset:12288
    ds_read_b128 v[128:131], v183 offset:0
    ds_read_b128 v[144:147], v183 offset:4096
    ds_read_b128 v[160:163], v183 offset:8192
    ds_read_b128 v[176:179], v183 offset:12288
    s_mov_b32 s87, 262144
    s_branch Lq_9
Lp_7:
    buffer_load_dwordx4 v[40:43], v22, s[44:47], s13 offen sc1
    buffer_load_dwordx4 v[44:47], v22, s[44:47], s13 offen offset:1024 sc1
Lq_9:
    s_waitcnt vmcnt(0)
    v_bitop3_b32 v32, v40, v41, s76 bitop3:0x7e
    v_bitop3_b32 v33, v42, v43, s76 bitop3:0x7e
    v_bitop3_b32 v34, v44, v45, s76 bitop3:0x7e
    v_bitop3_b32 v35, v46, v47, s76 bitop3:0x7e
    v_or3_b32 v32, v32, v33, v34
    v_or_b32 v32, v32, v35
    v_and_b32 v32, v10, v32
    v_cmp_ne_u32 vcc, 0, v32
    s_cbranch_vccz Ld_8
    s_sub_u32 s87, s87, 1
    s_cbranch_scc0 Lp_7
Ld_8:
    ds_add_u32 v184, v187 offset:28
    v_bfi_b32 v40, v10, 0, v40
    v_bfi_b32 v41, v10, 0, v41
    v_bfi_b32 v42, v10, 0, v42
    v_bfi_b32 v43, v10, 0, v43
    v_bfi_b32 v44, v10, 0, v44
    v_bfi_b32 v45, v10, 0, v45
    v_bfi_b32 v46, v10, 0, v46
    v_bfi_b32 v47, v10, 0, v47
    v_add_f32 v40, v40, v44
    v_add_f32 v41, v41, v45
    v_add_f32 v42, v42, v46
    v_add_f32 v43, v43, v47
    s_nop 0
    v_permlane32_swap_b32 v40, v42
    v_permlane32_swap_b32 v41, v43
    v_add_f32 v40, v40, v42
    v_add_f32 v41, v41, v43
    v_cvt_pk_bf16_f32 v40, v40, v41
    ds_write_b32 v21, v40 offset:0
    s_waitcnt lgkmcnt(0)
    ds_read_b128 v[56:59], v23 offset:0
    ds_read_b128 v[60:63], v23 offset:64
    ds_read_b128 v[64:67], v23 offset:128
    ds_read_b128 v[68:71], v23 offset:192
    s_waitcnt lgkmcnt(3)
    v_mfma_f32_16x16x32_bf16 v[72:75], v[116:119], v[56:59], 0
    v_mfma_f32_16x16x32_bf16 v[76:79], v[132:135], v[56:59], 0
    v_mfma_f32_16x16x32_bf16 v[80:83], v[148:151], v[56:59], 0
    v_mfma_f32_16x16x32_bf16 v[84:87], v[164:167], v[56:59], 0
    s_waitcnt lgkmcnt(2)
    v_mfma_f32_16x16x32_bf16 v[72:75], v[120:123], v[60:63], v[72:75]
    v_mfma_f32_16x16x32_bf16 v[76:79], v[136:139], v[60:63], v[76:79]
    v_mfma_f32_16x16x32_bf16 v[80:83], v[152:155], v[60:63], v[80:83]
    v_mfma_f32_16x16x32_bf16 v[84:87], v[168:171], v[60:63], v[84:87]
    s_waitcnt lgkmcnt(1)
    v_mfma_f32_16x16x32_bf16 v[72:75], v[124:127], v[64:67], v[72:75]
    v_mfma_f32_16x16x32_bf16 v[76:79], v[140:143], v[64:67], v[76:79]
    v_mfma_f32_16x16x32_bf16 v[80:83], v[156:159], v[64:67], v[80:83]
    v_mfma_f32_16x16x32_bf16 v[84:87], v[172:175], v[64:67], v[84:87]
    s_waitcnt lgkmcnt(0)
    v_mfma_f32_16x16x32_bf16 v[72:75], v[128:131], v[68:71], v[72:75]
    v_mfma_f32_16x16x32_bf16 v[76:79], v[144:147], v[68:71], v[76:79]
    v_mfma_f32_16x16x32_bf16 v[80:83], v[160:163], v[68:71], v[80:83]
    v_mfma_f32_16x16x32_bf16 v[84:87], v[176:179], v[68:71], v[84:87]
    s_lshl_b32 s4, s83, 13
    s_lshl_b32 s5, s8, 11
    s_add_u32 s4, s4, s5
    s_add_u32 s13, s4, 6815744
    s_add_u32 s12, s13, 4096
    s_mov_b32 exec_lo, 0xf000f
    s_mov_b32 exec_hi, 0xf000f
    v_cndmask_b32 v72, v72, v76, s[72:73]
    v_cndmask_b32 v73, v73, v77, s[72:73]
    v_cndmask_b32 v74, v74, v78, s[72:73]
    v_cndmask_b32 v75, v75, v79, s[72:73]
    v_cndmask_b32 v72, v72, v80, s[6:7]
    v_cndmask_b32 v73, v73, v81, s[6:7]
    v_cndmask_b32 v74, v74, v82, s[6:7]
    v_cndmask_b32 v75, v75, v83, s[6:7]
    v_cndmask_b32 v72, v72, v84, s[10:11]
    v_cndmask_b32 v73, v73, v85, s[10:11]
    v_cndmask_b32 v74, v74, v86, s[10:11]
    v_cndmask_b32 v75, v75, v87, s[10:11]
    v_add_u32 v72, 0x10000, v72
    v_add_u32 v73, 0x10000, v73
    v_add_u32 v74, 0x10000, v74
    v_add_u32 v75, 0x10000, v75
    v_perm_b32 v72, v73, v72, v253
    v_perm_b32 v73, v75, v74, v253
    v_bfi_b32 v72, v11, s78, v72
    v_bfi_b32 v73, v11, s78, v73
    buffer_store_dwordx2 v[72:73], v188, s[44:47], s9 offen sc1
    s_mov_b64 exec, -1
    ds_add_u32 v184, v187 offset:8
    s_call_b64 s[24:25], L_baddr
    s_lshl_b32 s9, s8, 9
    s_add_u32 s9, s9, 132096
    v_add_u32 v21, s9, v185
    v_and_b32 v4, 1, v2
    v_lshlrev_b32 v4, 8, v4
    v_lshl_add_u32 v4, v3, 4, v4
    v_add_u32 v23, s9, v4
    s_lshl_b32 s5, s8, 15
    v_add_u32 v180, s5, v186
    v_xor_b32 v181, 64, v180
    v_xor_b32 v182, 0x80, v180
    v_xor_b32 v183, 0xc0, v180
    v_lshlrev_b32 v189, 8, v2
    v_lshl_add_u32 v4, v3, 4, v189
    s_lshl_b32 s4, s8, 9
    s_add_u32 s4, s4, 133120
    v_add_u32 v190, s4, v4
    s_lshl_b32 s9, s83, 9
    s_lshl_b32 s5, s84, 1
    s_add_u32 s5, s5, s8
    s_lshl_b32 s5, s5, 4
    s_add_u32 s9, s9, s5
    s_add_u32 s9, s9, 393216
    s_load_dwordx4 s[92:95], s[40:41], s90
    s_waitcnt lgkmcnt(0)
    s_mov_b32 s85, 1
    s_cmp_eq_u64 s[92:93], s[100:101]
    s_cselect_b32 s85, s85, 0
    s_cmp_eq_u64 s[94:95], s[100:101]
    s_cselect_b32 s85, s85, 0
    s_cmp_eq_u32 s85, 1
    s_cbranch_scc1 Lgl_10
    v_and_b32 v4, 3, v1
    v_lshl_add_u32 v4, v4, 2, s90
    global_load_dword v4, v4, s[40:41] sc1
    s_waitcnt vmcnt(0)
    v_cmp_ne_u32 vcc, s100, v4
    s_nop 0
    s_cmp_eq_u64 vcc, 0
    s_cselect_b32 s85, 1, 0
Lgl_10:
    v_mov_b32 v5, 135188
    s_mov_b32 s87, 1048576
Lf_11:
    ds_read_b32 v4, v5
    s_waitcnt lgkmcnt(0)
    v_cmp_gt_u32 vcc, 0x80, v4
    s_cbranch_vccz Lg_12
    s_sub_u32 s87, s87, 1
    s_cbranch_scc0 Lf_11
Lg_12:
    s_mov_b32 s87, 262144
Lp_13:
    buffer_load_dwordx4 v[40:43], v22, s[44:47], s13 offen offset:0 sc1
    buffer_load_dwordx4 v[44:47], v22, s[44:47], s13 offen offset:1024 sc1
    buffer_load_dwordx4 v[48:51], v22, s[44:47], s12 offen offset:0 sc1
    buffer_load_dwordx4 v[52:55], v22, s[44:47], s12 offen offset:1024 sc1
    s_waitcnt vmcnt(0)
    v_bitop3_b32 v72, v40, v41, s77 bitop3:0x7e
    v_bitop3_b32 v73, v42, v43, s77 bitop3:0x7e
    v_bitop3_b32 v74, v44, v45, s77 bitop3:0x7e
    v_bitop3_b32 v75, v46, v47, s77 bitop3:0x7e
    v_bitop3_b32 v76, v48, v49, s77 bitop3:0x7e
    v_bitop3_b32 v77, v50, v51, s77 bitop3:0x7e
    v_bitop3_b32 v78, v52, v53, s77 bitop3:0x7e
    v_bitop3_b32 v79, v54, v55, s77 bitop3:0x7e
    v_or3_b32 v72, v72, v73, v74
    v_or3_b32 v75, v75, v76, v77
    v_or_b32 v78, v78, v79
    v_or3_b32 v72, v72, v75, v78
    v_and_b32 v72, v10, v72
    v_cmp_ne_u32 vcc, 0, v72
    s_cbranch_vccz Ld_14
    s_sub_u32 s87, s87, 1
    s_cbranch_scc0 Lp_13
Ld_14:
    v_bfi_b32 v40, v10, 0, v40
    v_bfi_b32 v41, v10, 0, v41
    v_bfi_b32 v42, v10, 0, v42
    v_bfi_b32 v43, v10, 0, v43
    v_bfi_b32 v44, v10, 0, v44
    v_bfi_b32 v45, v10, 0, v45
    v_bfi_b32 v46, v10, 0, v46
    v_bfi_b32 v47, v10, 0, v47
    v_add_f32 v40, v40, v44
    v_add_f32 v41, v41, v45
    v_add_f32 v42, v42, v46
    v_add_f32 v43, v43, v47
    s_nop 0
    v_permlane32_swap_b32 v40, v42
    v_permlane32_swap_b32 v41, v43
    v_add_f32 v40, v40, v42
    v_add_f32 v41, v41, v43
    v_cvt_pk_bf16_f32 v40, v40, v41
    ds_write_b32 v21, v40 offset:0
    v_bfi_b32 v48, v10, 0, v48
    v_bfi_b32 v49, v10, 0, v49
    v_bfi_b32 v50, v10, 0, v50
    v_bfi_b32 v51, v10, 0, v51
    v_bfi_b32 v52, v10, 0, v52
    v_bfi_b32 v53, v10, 0, v53
    v_bfi_b32 v54, v10, 0, v54
    v_bfi_b32 v55, v10, 0, v55
    v_add_f32 v48, v48, v52
    v_add_f32 v49, v49, v53
    v_add_f32 v50, v50, v54
    v_add_f32 v51, v51, v55
    s_nop 0
    v_permlane32_swap_b32 v48, v50
    v_permlane32_swap_b32 v49, v51
    v_add_f32 v48, v48, v50
    v_add_f32 v49, v49, v51
    v_cvt_pk_bf16_f32 v48, v48, v49
    ds_write_b32 v21, v48 offset:256
    s_waitcnt lgkmcnt(0)
    ds_read_b128 v[56:59], v23 offset:0
    ds_read_b128 v[60:63], v23 offset:64
    ds_read_b128 v[64:67], v23 offset:128
    ds_read_b128 v[68:71], v23 offset:192
    s_add_u32 s5, s8, 2
    s_mov_b32 s87, 1048576
Lf_16:
    ds_read_b32 v4, v184
    s_waitcnt lgkmcnt(0)
    v_cmp_gt_u32 vcc, s5, v4
    s_cbranch_vccz Lg_17
    s_sub_u32 s87, s87, 1
    s_cbranch_scc0 Lf_16
Lg_17:
    ds_read_b128 v[72:75], v180 offset:0
    ds_read_b128 v[76:79], v181 offset:0
    ds_read_b128 v[80:83], v182 offset:0
    ds_read_b128 v[84:87], v183 offset:0
    ds_read_b128 v[88:91], v180 offset:4096
    ds_read_b128 v[92:95], v181 offset:4096
    ds_read_b128 v[96:99], v182 offset:4096
    ds_read_b128 v[100:103], v183 offset:4096
    s_waitcnt lgkmcnt(7)
    v_mfma_f32_16x16x32_bf16 v[112:115], v[72:75], v[56:59], 0
    ds_read_b128 v[72:75], v180 offset:8192
    s_waitcnt lgkmcnt(7)
    v_mfma_f32_16x16x32_bf16 v[112:115], v[76:79], v[60:63], v[112:115]
    ds_read_b128 v[76:79], v181 offset:8192
    s_waitcnt lgkmcnt(7)
    v_mfma_f32_16x16x32_bf16 v[112:115], v[80:83], v[64:67], v[112:115]
    ds_read_b128 v[80:83], v182 offset:8192
    s_waitcnt lgkmcnt(7)
    v_mfma_f32_16x16x32_bf16 v[112:115], v[84:87], v[68:71], v[112:115]
    ds_read_b128 v[84:87], v183 offset:8192
    s_waitcnt lgkmcnt(7)
    v_mfma_f32_16x16x32_bf16 v[116:119], v[88:91], v[56:59], 0
    ds_read_b128 v[88:91], v180 offset:12288
    s_waitcnt lgkmcnt(7)
    v_mfma_f32_16x16x32_bf16 v[116:119], v[92:95], v[60:63], v[116:119]
    ds_read_b128 v[92:95], v181 offset:12288
    s_waitcnt lgkmcnt(7)
    v_mfma_f32_16x16x32_bf16 v[116:119], v[96:99], v[64:67], v[116:119]
    ds_read_b128 v[96:99], v182 offset:12288
    s_waitcnt lgkmcnt(7)
    v_mfma_f32_16x16x32_bf16 v[116:119], v[100:103], v[68:71], v[116:119]
    ds_read_b128 v[100:103], v183 offset:12288
    s_waitcnt lgkmcnt(7)
    v_mfma_f32_16x16x32_bf16 v[120:123], v[72:75], v[56:59], 0
    ds_read_b128 v[72:75], v180 offset:16384
    s_waitcnt lgkmcnt(7)
    v_mfma_f32_16x16x32_bf16 v[120:123], v[76:79], v[60:63], v[120:123]
    ds_read_b128 v[76:79], v181 offset:16384
    s_waitcnt lgkmcnt(7)
    v_mfma_f32_16x16x32_bf16 v[120:123], v[80:83], v[64:67], v[120:123]
    ds_read_b128 v[80:83], v182 offset:16384
    s_waitcnt lgkmcnt(7)
    v_mfma_f32_16x16x32_bf16 v[120:123], v[84:87], v[68:71], v[120:123]
    ds_read_b128 v[84:87], v183 offset:16384
    s_waitcnt lgkmcnt(7)
    v_mfma_f32_16x16x32_bf16 v[124:127], v[88:91], v[56:59], 0
    ds_read_b128 v[88:91], v180 offset:20480
    s_waitcnt lgkmcnt(7)
    v_mfma_f32_16x16x32_bf16 v[124:127], v[92:95], v[60:63], v[124:127]
    ds_read_b128 v[92:95], v181 offset:20480
    s_waitcnt lgkmcnt(7)
    v_mfma_f32_16x16x32_bf16 v[124:127], v[96:99], v[64:67], v[124:127]
    ds_read_b128 v[96:99], v182 offset:20480
    s_waitcnt lgkmcnt(7)
    v_mfma_f32_16x16x32_bf16 v[124:127], v[100:103], v[68:71], v[124:127]
    ds_read_b128 v[100:103], v183 offset:20480
    s_waitcnt lgkmcnt(7)
    v_mfma_f32_16x16x32_bf16 v[128:131], v[72:75], v[56:59], 0
    ds_read_b128 v[72:75], v180 offset:24576
    s_waitcnt lgkmcnt(7)
    v_mfma_f32_16x16x32_bf16 v[128:131], v[76:79], v[60:63], v[128:131]
    ds_read_b128 v[76:79], v181 offset:24576
    s_waitcnt lgkmcnt(7)
    v_mfma_f32_16x16x32_bf16 v[128:131], v[80:83], v[64:67], v[128:131]
    ds_read_b128 v[80:83], v182 offset:24576
    s_waitcnt lgkmcnt(7)
    v_mfma_f32_16x16x32_bf16 v[128:131], v[84:87], v[68:71], v[128:131]
    ds_read_b128 v[84:87], v183 offset:24576
    s_waitcnt lgkmcnt(7)
    v_mfma_f32_16x16x32_bf16 v[132:135], v[88:91], v[56:59], 0
    ds_read_b128 v[88:91], v180 offset:28672
    s_waitcnt lgkmcnt(7)
    v_mfma_f32_16x16x32_bf16 v[132:135], v[92:95], v[60:63], v[132:135]
    ds_read_b128 v[92:95], v181 offset:28672
    s_waitcnt lgkmcnt(7)
    v_mfma_f32_16x16x32_bf16 v[132:135], v[96:99], v[64:67], v[132:135]
    ds_read_b128 v[96:99], v182 offset:28672
    s_waitcnt lgkmcnt(7)
    v_mfma_f32_16x16x32_bf16 v[132:135], v[100:103], v[68:71], v[132:135]
    ds_read_b128 v[100:103], v183 offset:28672
    s_waitcnt lgkmcnt(7)
    v_mfma_f32_16x16x32_bf16 v[136:139], v[72:75], v[56:59], 0
    s_waitcnt lgkmcnt(6)
    v_mfma_f32_16x16x32_bf16 v[136:139], v[76:79], v[60:63], v[136:139]
    s_waitcnt lgkmcnt(5)
    v_mfma_f32_16x16x32_bf16 v[136:139], v[80:83], v[64:67], v[136:139]
    s_waitcnt lgkmcnt(4)
    v_mfma_f32_16x16x32_bf16 v[136:139], v[84:87], v[68:71], v[136:139]
    s_waitcnt lgkmcnt(3)
    v_mfma_f32_16x16x32_bf16 v[140:143], v[88:91], v[56:59], 0
    s_waitcnt lgkmcnt(2)
    v_mfma_f32_16x16x32_bf16 v[140:143], v[92:95], v[60:63], v[140:143]
    s_waitcnt lgkmcnt(1)
    v_mfma_f32_16x16x32_bf16 v[140:143], v[96:99], v[64:67], v[140:143]
    s_waitcnt lgkmcnt(0)
    v_mfma_f32_16x16x32_bf16 v[140:143], v[100:103], v[68:71], v[140:143]
    ds_add_u32 v184, v187 offset:4
    v_max3_f32 v40, v112, v113, v114
    v_max3_f32 v40, v40, v115, v116
    v_max3_f32 v40, v40, v117, v118
    v_max3_f32 v40, v40, v119, v120
    v_max3_f32 v40, v40, v121, v122
    v_max3_f32 v40, v40, v123, v124
    v_max3_f32 v40, v40, v125, v126
    v_max3_f32 v40, v40, v127, v128
    v_max3_f32 v40, v40, v129, v130
    v_max3_f32 v40, v40, v131, v132
    v_max3_f32 v40, v40, v133, v134
    v_max3_f32 v40, v40, v135, v136
    v_max3_f32 v40, v40, v137, v138
    v_max3_f32 v40, v40, v139, v140
    v_max3_f32 v40, v40, v141, v142
    v_max_f32 v40, v40, v143
    v_mov_b32 v4, v40
    s_nop 1
    v_permlane16_swap_b32 v40, v4
    v_max_f32 v40, v40, v4
    v_mov_b32 v4, v40
    s_nop 1
    v_permlane32_swap_b32 v40, v4
    v_max_f32 v40, v40, v4
    v_mul_f32 v40, s88, v40
    v_fma_f32 v112, v112, s88, -v40
    v_fma_f32 v113, v113, s88, -v40
    v_fma_f32 v114, v114, s88, -v40
    v_fma_f32 v115, v115, s88, -v40
    v_fma_f32 v116, v116, s88, -v40
    v_fma_f32 v117, v117, s88, -v40
    v_fma_f32 v118, v118, s88, -v40
    v_fma_f32 v119, v119, s88, -v40
    v_fma_f32 v120, v120, s88, -v40
    v_fma_f32 v121, v121, s88, -v40
    v_fma_f32 v122, v122, s88, -v40
    v_fma_f32 v123, v123, s88, -v40
    v_fma_f32 v124, v124, s88, -v40
    v_fma_f32 v125, v125, s88, -v40
    v_fma_f32 v126, v126, s88, -v40
    v_fma_f32 v127, v127, s88, -v40
    v_fma_f32 v128, v128, s88, -v40
    v_fma_f32 v129, v129, s88, -v40
    v_fma_f32 v130, v130, s88, -v40
    v_fma_f32 v131, v131, s88, -v40
    v_fma_f32 v132, v132, s88, -v40
    v_fma_f32 v133, v133, s88, -v40
    v_fma_f32 v134, v134, s88, -v40
    v_fma_f32 v135, v135, s88, -v40
    v_fma_f32 v136, v136, s88, -v40
    v_fma_f32 v137, v137, s88, -v40
    v_fma_f32 v138, v138, s88, -v40
    v_fma_f32 v139, v139, s88, -v40
    v_fma_f32 v140, v140, s88, -v40
    v_fma_f32 v141, v141, s88, -v40
    v_fma_f32 v142, v142, s88, -v40
    v_fma_f32 v143, v143, s88, -v40
    v_exp_f32 v112, v112
    v_exp_f32 v113, v113
    v_exp_f32 v114, v114
    v_exp_f32 v115, v115
    v_exp_f32 v116, v116
    v_exp_f32 v117, v117
    v_exp_f32 v118, v118
    v_exp_f32 v119, v119
    v_exp_f32 v120, v120
    v_exp_f32 v121, v121
    v_exp_f32 v122, v122
    v_exp_f32 v123, v123
    v_exp_f32 v124, v124
    v_exp_f32 v125, v125
    v_exp_f32 v126, v126
    v_exp_f32 v127, v127
    v_exp_f32 v128, v128
    v_exp_f32 v129, v129
    v_exp_f32 v130, v130
    v_exp_f32 v131, v131
    v_exp_f32 v132, v132
    v_exp_f32 v133, v133
    v_exp_f32 v134, v134
    v_exp_f32 v135, v135
    v_exp_f32 v136, v136
    v_exp_f32 v137, v137
    v_exp_f32 v138, v138
    v_exp_f32 v139, v139
    v_exp_f32 v140, v140
    v_exp_f32 v141, v141
    v_exp_f32 v142, v142
    v_exp_f32 v143, v143
    v_add_f32 v41, v112, v113
    v_add_f32 v42, v114, v115
    v_add_f32 v41, v41, v116
    v_add_f32 v42, v42, v117
    v_add_f32 v41, v41, v118
    v_add_f32 v42, v42, v119
    v_add_f32 v41, v41, v120
    v_add_f32 v42, v42, v121
    v_add_f32 v41, v41, v122
    v_add_f32 v42, v42, v123
    v_add_f32 v41, v41, v124
    v_add_f32 v42, v42, v125
    v_add_f32 v41, v41, v126
    v_add_f32 v42, v42, v127
    v_add_f32 v41, v41, v128
    v_add_f32 v42, v42, v129
    v_add_f32 v41, v41, v130
    v_add_f32 v42, v42, v131
    v_add_f32 v41, v41, v132
    v_add_f32 v42, v42, v133
    v_add_f32 v41, v41, v134
    v_add_f32 v42, v42, v135
    v_add_f32 v41, v41, v136
    v_add_f32 v42, v42, v137
    v_add_f32 v41, v41, v138
    v_add_f32 v42, v42, v139
    v_add_f32 v41, v41, v140
    v_add_f32 v42, v42, v141
    v_add_f32 v41, v41, v142
    v_add_f32 v42, v42, v143
    v_add_f32 v41, v41, v42
    v_cvt_pk_bf16_f32 v72, v112, v113
    v_cvt_pk_bf16_f32 v73, v114, v115
    v_cvt_pk_bf16_f32 v74, v116, v117
    v_cvt_pk_bf16_f32 v75, v118, v119
    v_cvt_pk_bf16_f32 v76, v120, v121
    v_cvt_pk_bf16_f32 v77, v122, v123
    v_cvt_pk_bf16_f32 v78, v124, v125
    v_cvt_pk_bf16_f32 v79, v126, v127
    v_cvt_pk_bf16_f32 v80, v128, v129
    v_cvt_pk_bf16_f32 v81, v130, v131
    v_cvt_pk_bf16_f32 v82, v132, v133
    v_cvt_pk_bf16_f32 v83, v134, v135
    v_cvt_pk_bf16_f32 v84, v136, v137
    v_cvt_pk_bf16_f32 v85, v138, v139
    v_cvt_pk_bf16_f32 v86, v140, v141
    v_cvt_pk_bf16_f32 v87, v142, v143
    v_mov_b32 v4, v41
    s_nop 1
    v_permlane16_swap_b32 v41, v4
    v_add_f32 v41, v41, v4
    v_mov_b32 v4, v41
    s_nop 1
    v_permlane32_swap_b32 v41, v4
    v_add_f32 v41, v41, v4
    v_mov_b32 v42, s77
    v_mov_b32 v43, s77
    s_mov_b32 exec_lo, 0x30003
    s_mov_b32 exec_hi, 0x30003
    ds_write_b128 v190, v[72:75] offset:0
    ds_write_b128 v190, v[76:79] offset:64
    ds_write_b128 v190, v[80:83] offset:128
    ds_write_b128 v190, v[84:87] offset:192
    s_cmp_eq_u32 s85, 1
    s_cbranch_scc1 Ls_18
    buffer_store_dwordx4 v[40:43], v189, s[44:47], s9 offen sc1
    s_branch Ls_19
Ls_18:
    buffer_store_dwordx4 v[40:43], v189, s[44:47], s9 offen
Ls_19:
    s_mov_b64 exec, -1
    s_waitcnt lgkmcnt(0)
    s_branch L_B3
L_Pidle:
    v_mov_b32 v4, 135168
    v_mov_b32 v6, 0
    v_mov_b32 v7, 0
    ds_write_b64 v4, v[6:7]
    ds_write_b64 v4, v[6:7] offset:8
    ds_write_b64 v4, v[6:7] offset:16
    ds_write_b64 v4, v[6:7] offset:24
    s_waitcnt lgkmcnt(0)
    s_mov_b64 s[44:45], s[42:43]
    s_barrier
    s_load_dwordx2 s[76:77], s[42:43], 0
    s_cmp_eq_u32 s3, 6
    s_cbranch_scc0 Lip_20
    s_getpc_b64 s[4:5]
Lpc_21:
    s_add_u32 s4, s4, L_s1-Lpc_21
    s_addc_u32 s5, s5, -1
    s_cmp_ge_i32 L_s1-Lpc_21, 0
    s_cselect_b32 s6, 1, 0
    s_add_u32 s5, s5, s6
    s_mov_b32 s6, L_Sidle-L_s1
    s_mov_b32 s7, 0x20000
    s_lshr_b32 s12, s86, 3
    s_lshl_b32 s12, s12, 10
    v_lshlrev_b32 v4, 4, v1
    buffer_load_dwordx4 v[40:43], v4, s[4:7], s12 offen
    s_waitcnt vmcnt(0)
Lip_20:
    s_call_b64 s[24:25], L_baddr
    s_cmp_eq_u32 s3, 5
    s_cbranch_scc0 L_pv1
    v_lshlrev_b32 v14, 4, v1
    s_lshl_b32 s4, s83, 3
    s_add_u32 s4, s4, s84
    s_lshl_b32 s4, s4, 10
    s_add_u32 s4, s4, 6815744
    buffer_load_dwordx4 v[40:43], v14, s[44:47], s4 offen offset:0 sc1
    buffer_load_dwordx4 v[44:47], v241, s[44:47], 0 offen sc1
    buffer_load_dwordx4 v[48:51], v237, s[44:47], 0 offen sc1
L_pv1:
    s_waitcnt lgkmcnt(0)
    s_add_u32 s76, s76, 1
    s_and_b32 s12, s76, 2
    s_lshl_b32 s12, s12, 15
    s_and_b32 s78, s76, 1
    s_or_b32 s78, s78, s12
    s_add_u32 s77, s77, 1
    s_and_b32 s12, s77, 2
    s_lshl_b32 s12, s12, 15
    s_and_b32 s79, s77, 1
    s_or_b32 s79, s79, s12
    s_cmp_gt_u32 s3, 4
    s_cbranch_scc1 L_pb1
    s_mov_b64 s[48:49], s[28:29]
    s_mov_b64 s[52:53], s[34:35]
    s_sub_u32 s7, s3, 3
    v_lshrrev_b32 v4, 3, v1
    v_mul_u32_u24 v22, 36, v4
    v_mul_u32_u24 v21, 147456, v4
    v_and_b32 v4, 7, v1
    v_lshl_add_u32 v21, v4, 4, v21
    s_mul_i32 s12, s80, 288
    s_mul_i32 s13, s80, 1179648
    s_lshl_b32 s4, s82, 8
    s_add_u32 s13, s13, s4
    s_lshl_b32 s4, s7, 7
    s_add_u32 s13, s13, s4
    v_and_b32 v4, 7, v1
    v_lshlrev_b32 v4, 5, v4
    v_lshl_add_u32 v9, v3, 3, v4
    v_bfe_u32 v4, v1, 3, 1
    v_lshl_add_u32 v9, v4, 11, v9
    s_lshl_b32 s26, s82, 12
    s_lshl_b32 s5, s80, 9
    s_add_u32 s26, s26, s5
    s_lshl_b32 s5, s7, 8
    s_add_u32 s26, s26, s5
    s_add_u32 s26, s26, 6815744
    s_mov_b32 s27, s77
    v_mov_b32 v23, 135196
    v_mov_b32 v187, 1
    s_mov_b32 s87, 1048576
Lf_22:
    ds_read_b32 v4, v23
    s_waitcnt lgkmcnt(0)
    v_cmp_gt_u32 vcc, 0x80, v4
    s_cbranch_vccz Lg_23
    s_sub_u32 s87, s87, 1
    s_cbranch_scc0 Lf_22
Lg_23:
    v_mov_b32 v23, 135176
    buffer_load_dwordx4 v[12:15], v22, s[48:51], s12 offen
    buffer_load_dwordx4 v[16:19], v22, s[48:51], s12 offen offset:16
    buffer_load_dword v20, v22, s[48:51], s12 offen offset:32
    buffer_load_dwordx4 v[40:43], v21, s[52:55], s13 offen nt
    s_add_u32 s13, s13, 8192
    buffer_load_dwordx4 v[44:47], v21, s[52:55], s13 offen nt
    s_add_u32 s13, s13, 8192
    buffer_load_dwordx4 v[48:51], v21, s[52:55], s13 offen nt
    s_add_u32 s13, s13, 8192
    buffer_load_dwordx4 v[52:55], v21, s[52:55], s13 offen nt
    s_add_u32 s13, s13, 8192
    buffer_load_dwordx4 v[56:59], v21, s[52:55], s13 offen nt
    s_add_u32 s13, s13, 8192
    buffer_load_dwordx4 v[60:63], v21, s[52:55], s13 offen nt
    s_add_u32 s13, s13, 8192
    buffer_load_dwordx4 v[64:67], v21, s[52:55], s13 offen nt
    s_add_u32 s13, s13, 8192
    buffer_load_dwordx4 v[68:71], v21, s[52:55], s13 offen nt
    s_add_u32 s13, s13, 8192
    buffer_load_dwordx4 v[72:75], v21, s[52:55], s13 offen nt
    s_add_u32 s13, s13, 8192
    buffer_load_dwordx4 v[76:79], v21, s[52:55], s13 offen nt
    s_add_u32 s13, s13, 8192
    buffer_load_dwordx4 v[80:83], v21, s[52:55], s13 offen nt
    s_add_u32 s13, s13, 8192
    buffer_load_dwordx4 v[84:87], v21, s[52:55], s13 offen nt
    s_add_u32 s13, s13, 8192
    s_mov_b32 s87, 1048576
Lf_24:
    ds_read_b32 v4, v23
    s_waitcnt lgkmcnt(0)
    v_cmp_gt_u32 vcc, 0x80, v4
    s_cbranch_vccz Lg_25
    s_sub_u32 s87, s87, 1
    s_cbranch_scc0 Lf_24
Lg_25:
    buffer_load_dwordx4 v[88:91], v21, s[52:55], s13 offen nt
    s_add_u32 s13, s13, 8192
    buffer_load_dwordx4 v[92:95], v21, s[52:55], s13 offen nt
    s_add_u32 s13, s13, 8192
    buffer_load_dwordx4 v[96:99], v21, s[52:55], s13 offen nt
    s_add_u32 s13, s13, 8192
    buffer_load_dwordx4 v[100:103], v21, s[52:55], s13 offen nt
    s_add_u32 s13, s13, 8192
    buffer_load_dwordx4 v[104:107], v21, s[52:55], s13 offen nt
    s_add_u32 s13, s13, 8192
    buffer_load_dwordx4 v[108:111], v21, s[52:55], s13 offen nt
    ds_add_u32 v23, v187 offset:8
    s_call_b64 s[24:25], L_s1
    ds_add_u32 v23, v187 offset:12
    s_load_dwordx4 s[92:95], s[40:41], s90
    s_waitcnt lgkmcnt(0)
    s_mov_b32 s85, 1
    s_cmp_eq_u64 s[92:93], s[100:101]
    s_cselect_b32 s85, s85, 0
    s_cmp_eq_u64 s[94:95], s[100:101]
    s_cselect_b32 s85, s85, 0
    s_cmp_eq_u32 s85, 1
    s_cbranch_scc1 Lgl_26
    v_and_b32 v4, 3, v1
    v_lshl_add_u32 v4, v4, 2, s90
    global_load_dword v4, v4, s[40:41] sc1
    s_waitcnt vmcnt(0)
    v_cmp_ne_u32 vcc, s100, v4
    s_nop 0
    s_cmp_eq_u64 vcc, 0
    s_cselect_b32 s85, 1, 0
Lgl_26:
    s_branch L_B3
L_pb1:
    v_mov_b32 v14, 135168
    s_mov_b32 s87, 1048576
Lf_27:
    ds_read_b32 v4, v14
    s_waitcnt lgkmcnt(0)
    v_cmp_gt_u32 vcc, 3, v4
    s_cbranch_vccz Lg_28
    s_sub_u32 s87, s87, 1
    s_cbranch_scc0 Lf_27
Lg_28:
    s_cmp_eq_u32 s3, 5
    s_cbranch_scc0 L_fpb
    s_cmp_lt_u32 s86, 36
    s_cbranch_scc0 L_fpb
    v_lshlrev_b32 v14, 4, v1
    s_lshl_b32 s4, s86, 13
    s_add_u32 s4, s4, 5537792
    buffer_load_dwordx4 v[40:43], v14, s[44:47], s4 offen offset:0 sc1
    buffer_load_dwordx4 v[44:47], v14, s[44:47], s4 offen offset:1024 sc1
    buffer_load_dwordx4 v[48:51], v14, s[44:47], s4 offen offset:2048 sc1
    buffer_load_dwordx4 v[52:55], v14, s[44:47], s4 offen offset:3072 sc1
    s_add_u32 s4, s4, 4096
    buffer_load_dwordx4 v[56:59], v14, s[44:47], s4 offen offset:0 sc1
    buffer_load_dwordx4 v[60:63], v14, s[44:47], s4 offen offset:1024 sc1
    buffer_load_dwordx4 v[64:67], v14, s[44:47], s4 offen offset:2048 sc1
    buffer_load_dwordx4 v[68:71], v14, s[44:47], s4 offen offset:3072 sc1
L_fpb:
    s_load_dwordx4 s[92:95], s[40:41], s90
    s_waitcnt lgkmcnt(0)
    s_mov_b32 s85, 1
    s_cmp_eq_u64 s[92:93], s[100:101]
    s_cselect_b32 s85, s85, 0
    s_cmp_eq_u64 s[94:95], s[100:101]
    s_cselect_b32 s85, s85, 0
    s_cmp_eq_u32 s85, 1
    s_cbranch_scc1 Lgl_29
    v_and_b32 v4, 3, v1
    v_lshl_add_u32 v4, v4, 2, s90
    global_load_dword v4, v4, s[40:41] sc1
    s_waitcnt vmcnt(0)
    v_cmp_ne_u32 vcc, s100, v4
    s_nop 0
    s_cmp_eq_u64 vcc, 0
    s_cselect_b32 s85, 1, 0
Lgl_29:
    s_waitcnt vmcnt(0)
    s_branch L_B3
L_baddr:
    v_lshrrev_b32 v4, 2, v2
    v_lshl_add_u32 v5, v3, 2, v4
    v_and_b32 v6, 7, v5
    v_lshlrev_b32 v6, 1, v6
    v_bfe_u32 v7, v2, 1, 1
    v_xor_b32 v6, v6, v7
    s_and_b32 s4, s3, 3
    s_lshl_b32 s4, s4, 2
    v_xor_b32 v6, s4, v6
    v_lshlrev_b32 v5, 8, v5
    v_lshl_add_u32 v5, v6, 4, v5
    v_and_b32 v7, 1, v2
    v_lshl_add_u32 v5, v7, 3, v5
    s_lshr_b32 s6, s3, 2
    s_lshl_b32 s4, s6, 15
    s_add_u32 s4, s4, 65536
    v_add_u32 v208, s4, v5
    v_xor_b32 v209, 32, v208
    v_and_b32 v4, 1, v4
    v_lshlrev_b32 v4, 8, v4
    v_lshl_add_u32 v4, v3, 4, v4
    s_lshl_b32 s4, s6, 9
    s_add_u32 s4, s4, 133120
    v_add_u32 v219, s4, v4
    s_lshl_b32 s4, s83, 13
    s_and_b32 s5, s3, 3
    s_lshl_b32 s5, s5, 10
    s_add_u32 s4, s4, s5
    s_lshl_b32 s5, s84, 1
    s_add_u32 s5, s5, s6
    s_lshl_b32 s5, s5, 6
    s_add_u32 s4, s4, s5
    s_add_u32 s4, s4, 4718592
    v_lshlrev_b32 v4, 12, v3
    v_lshl_add_u32 v4, v2, 2, v4
    v_add_u32 v220, s4, v4
    v_and_b32 v4, 3, v2
    v_lshl_add_u32 v4, v3, 2, v4
    s_lshl_b32 s4, s82, 8
    s_add_u32 s4, s4, 393216
    v_lshl_add_u32 v237, v4, 4, s4
    v_lshrrev_b32 v4, 2, v2
    v_and_b32 v5, 1, v4
    v_lshrrev_b32 v6, 1, v4
    v_lshl_add_u32 v6, v3, 2, v6
    v_lshl_add_u32 v6, v5, 4, v6
    v_mul_u32_u24 v6, 1152, v6
    v_mul_i32_i24 v7, -161792, v5
    v_add_u32 v6, v6, v7
    v_and_b32 v7, 1, v3
    v_lshl_or_b32 v7, v5, 1, v7
    v_lshlrev_b32 v7, 1, v7
    v_bfe_u32 v8, v2, 1, 1
    v_xor_b32 v7, v7, v8
    s_and_b32 s4, s3, 3
    s_lshl_b32 s4, s4, 1
    v_xor_b32 v7, s4, v7
    v_lshl_add_u32 v6, v7, 4, v6
    v_and_b32 v8, 1, v2
    v_lshl_add_u32 v6, v8, 3, v6
    v_add_u32 v240, 144384, v6
    s_lshr_b32 s4, s3, 2
    s_lshl_b32 s4, s4, 7
    s_add_u32 s4, s4, 143360
    v_add_u32 v239, s4, v6
    s_lshl_b32 s4, s82, 2
    s_add_u32 s4, s4, s80
    s_mul_i32 s4, s4, 1024
    s_add_u32 s4, s4, 4718592
    v_lshlrev_b32 v241, 6, v2
    v_lshl_add_u32 v241, v3, 4, v241
    v_add_u32 v241, s4, v241
    s_lshl_b32 s4, s86, 6
    s_add_u32 s4, s4, 5537792
    s_lshl_b32 s5, s3, 13
    s_add_u32 s5, s5, s4
    v_lshlrev_b32 v242, 16, v3
    v_lshl_add_u32 v242, v2, 2, v242
    v_add_u32 v242, s5, v242
    s_and_b32 s5, s3, 3
    s_add_u32 s5, s5, 32
    s_lshl_b32 s5, s5, 13
    s_add_u32 s5, s5, s4
    v_lshlrev_b32 v243, 2, v2
    v_add_u32 v243, s5, v243
    s_setpc_b64 s[24:25]
L_Pload:
    v_add_u32 v4, 0, v3
    v_xor_b32 v4, v4, v2
    v_lshlrev_b32 v4, 4, v4
    v_lshl_add_u32 v40, v3, 8, v4
    v_lshl_add_u32 v112, v3, 13, v4
    v_add_u32 v4, 4, v3
    v_xor_b32 v4, v4, v2
    v_lshlrev_b32 v4, 4, v4
    v_lshl_add_u32 v41, v3, 8, v4
    v_lshl_add_u32 v113, v3, 13, v4
    v_add_u32 v4, 8, v3
    v_xor_b32 v4, v4, v2
    v_lshlrev_b32 v4, 4, v4
    v_lshl_add_u32 v42, v3, 8, v4
    v_lshl_add_u32 v114, v3, 13, v4
    v_add_u32 v4, 12, v3
    v_xor_b32 v4, v4, v2
    v_lshlrev_b32 v4, 4, v4
    v_lshl_add_u32 v43, v3, 8, v4
    v_lshl_add_u32 v115, v3, 13, v4
    s_lshl_b32 s5, s80, 20
    s_lshl_b32 s4, s81, 8
    s_add_u32 s12, s5, s4
    s_mov_b32 s9, 65536
    s_waitcnt lgkmcnt(0)
    s_mov_b64 s[44:45], s[42:43]
    s_mov_b64 s[68:69], s[22:23]
    s_barrier
L_lduk:
    s_mov_b32 m0, s9
    s_add_u32 s9, s9, 1024
    buffer_load_dwordx4 v112, s[68:71], s12 offen nt lds
    s_add_u32 s12, s12, 32768
    s_mov_b32 m0, s9
    s_add_u32 s9, s9, 1024
    buffer_load_dwordx4 v113, s[68:71], s12 offen nt lds
    s_add_u32 s12, s12, 32768
    s_mov_b32 m0, s9
    s_add_u32 s9, s9, 1024
    buffer_load_dwordx4 v114, s[68:71], s12 offen nt lds
    s_add_u32 s12, s12, 32768
    s_mov_b32 m0, s9
    s_add_u32 s9, s9, 1024
    buffer_load_dwordx4 v115, s[68:71], s12 offen nt lds
    s_add_u32 s12, s12, 32768
    s_cmp_lt_u32 s9, 98304
    s_cbranch_scc1 L_lduk
    s_load_dwordx2 s[76:77], s[42:43], 0
    v_lshl_add_u32 v4, v3, 1, 0
    v_xor_b32 v4, v4, v2
    v_lshlrev_b32 v4, 4, v4
    v_lshl_add_u32 v44, v3, 8, v4
    v_lshl_add_u32 v4, v3, 1, 8
    v_xor_b32 v4, v4, v2
    v_lshlrev_b32 v4, 4, v4
    v_lshl_add_u32 v45, v3, 8, v4
    s_mov_b64 s[60:61], s[30:31]
    s_mov_b32 s62, 33554432
    s_mov_b64 s[64:65], s[32:33]
    s_mov_b32 s66, 33554432
    s_mov_b32 s67, 0x20000
    s_mov_b64 s[56:57], s[36:37]
    s_lshl_b32 s8, s83, 21
    s_lshl_b32 s4, s84, 16
    s_add_u32 s8, s8, s4
    s_add_u32 s8, s8, 1572864
    s_mov_b32 s9, 0
    s_mul_i32 s10, s83, 4096
    v_mov_b32 v46, 135168
    v_mov_b32 v47, 1
    v_mov_b32 v48, 2
    v_mov_b32 v60, 3
    v_mov_b32 v61, 135184
    v_mov_b32 v59, 135172
    v_add_u32 v9, 0, v1
    v_mul_u32_u24 v4, 14564, v9
    v_lshrrev_b32 v4, 20, v4
    v_mul_u32_u24 v5, 72, v4
    v_sub_u32 v5, v9, v5
    v_lshrrev_b32 v50, 1, v4
    v_and_b32 v50, 2, v50
    v_xor_b32 v5, v5, v50
    v_lshrrev_b32 v50, 2, v4
    v_and_b32 v50, 4, v50
    v_xor_b32 v5, v5, v50
    v_mul_u32_u24 v4, 1152, v4
    v_lshl_add_u32 v50, v5, 4, v4
    v_add_u32 v9, 64, v1
    v_mul_u32_u24 v4, 14564, v9
    v_lshrrev_b32 v4, 20, v4
    v_mul_u32_u24 v5, 72, v4
    v_sub_u32 v5, v9, v5
    v_lshrrev_b32 v51, 1, v4
    v_and_b32 v51, 2, v51
    v_xor_b32 v5, v5, v51
    v_lshrrev_b32 v51, 2, v4
    v_and_b32 v51, 4, v51
    v_xor_b32 v5, v5, v51
    v_mul_u32_u24 v4, 1152, v4
    v_lshl_add_u32 v51, v5, 4, v4
    v_add_u32 v9, 128, v1
    v_mul_u32_u24 v4, 14564, v9
    v_lshrrev_b32 v4, 20, v4
    v_mul_u32_u24 v5, 72, v4
    v_sub_u32 v5, v9, v5
    v_lshrrev_b32 v52, 1, v4
    v_and_b32 v52, 2, v52
    v_xor_b32 v5, v5, v52
    v_lshrrev_b32 v52, 2, v4
    v_and_b32 v52, 4, v52
    v_xor_b32 v5, v5, v52
    v_mul_u32_u24 v4, 1152, v4
    v_lshl_add_u32 v52, v5, 4, v4
    v_add_u32 v9, 192, v1
    v_mul_u32_u24 v4, 14564, v9
    v_lshrrev_b32 v4, 20, v4
    v_mul_u32_u24 v5, 72, v4
    v_sub_u32 v5, v9, v5
    v_lshrrev_b32 v53, 1, v4
    v_and_b32 v53, 2, v53
    v_xor_b32 v5, v5, v53
    v_lshrrev_b32 v53, 2, v4
    v_and_b32 v53, 4, v53
    v_xor_b32 v5, v5, v53
    v_mul_u32_u24 v4, 1152, v4
    v_lshl_add_u32 v53, v5, 4, v4
    v_add_u32 v9, 256, v1
    v_mul_u32_u24 v4, 14564, v9
    v_lshrrev_b32 v4, 20, v4
    v_mul_u32_u24 v5, 72, v4
    v_sub_u32 v5, v9, v5
    v_lshrrev_b32 v54, 1, v4
    v_and_b32 v54, 2, v54
    v_xor_b32 v5, v5, v54
    v_lshrrev_b32 v54, 2, v4
    v_and_b32 v54, 4, v54
    v_xor_b32 v5, v5, v54
    v_mul_u32_u24 v4, 1152, v4
    v_lshl_add_u32 v54, v5, 4, v4
    v_add_u32 v9, 320, v1
    v_mul_u32_u24 v4, 14564, v9
    v_lshrrev_b32 v4, 20, v4
    v_mul_u32_u24 v5, 72, v4
    v_sub_u32 v5, v9, v5
    v_lshrrev_b32 v55, 1, v4
    v_and_b32 v55, 2, v55
    v_xor_b32 v5, v5, v55
    v_lshrrev_b32 v55, 2, v4
    v_and_b32 v55, 4, v55
    v_xor_b32 v5, v5, v55
    v_mul_u32_u24 v4, 1152, v4
    v_lshl_add_u32 v55, v5, 4, v4
    v_add_u32 v9, 384, v1
    v_mul_u32_u24 v4, 14564, v9
    v_lshrrev_b32 v4, 20, v4
    v_mul_u32_u24 v5, 72, v4
    v_sub_u32 v5, v9, v5
    v_lshrrev_b32 v56, 1, v4
    v_and_b32 v56, 2, v56
    v_xor_b32 v5, v5, v56
    v_lshrrev_b32 v56, 2, v4
    v_and_b32 v56, 4, v56
    v_xor_b32 v5, v5, v56
    v_mul_u32_u24 v4, 1152, v4
    v_lshl_add_u32 v56, v5, 4, v4
    v_add_u32 v9, 448, v1
    v_mul_u32_u24 v4, 14564, v9
    v_lshrrev_b32 v4, 20, v4
    v_mul_u32_u24 v5, 72, v4
    v_sub_u32 v5, v9, v5
    v_lshrrev_b32 v57, 1, v4
    v_and_b32 v57, 2, v57
    v_xor_b32 v5, v5, v57
    v_lshrrev_b32 v57, 2, v4
    v_and_b32 v57, 4, v57
    v_xor_b32 v5, v5, v57
    v_mul_u32_u24 v4, 1152, v4
    v_lshl_add_u32 v57, v5, 4, v4
    v_add_u32 v9, 512, v1
    v_mul_u32_u24 v4, 14564, v9
    v_lshrrev_b32 v4, 20, v4
    v_mul_u32_u24 v5, 72, v4
    v_sub_u32 v5, v9, v5
    v_lshrrev_b32 v58, 1, v4
    v_and_b32 v58, 2, v58
    v_xor_b32 v5, v5, v58
    v_lshrrev_b32 v58, 2, v4
    v_and_b32 v58, 4, v58
    v_xor_b32 v5, v5, v58
    v_mul_u32_u24 v4, 1152, v4
    v_lshl_add_u32 v58, v5, 4, v4
    s_call_b64 s[24:25], L_baddr
    s_waitcnt lgkmcnt(0)
    s_add_u32 s76, s76, 1
    s_and_b32 s12, s76, 2
    s_lshl_b32 s12, s12, 15
    s_and_b32 s78, s76, 1
    s_or_b32 s78, s78, s12
    s_add_u32 s77, s77, 1
    s_and_b32 s12, s77, 2
    s_lshl_b32 s12, s12, 15
    s_and_b32 s79, s77, 1
    s_or_b32 s79, s79, s12
    s_waitcnt vmcnt(0)
    ds_write_b32 v46, v47
    s_mov_b32 s87, 1048576
Lf_30:
    ds_read_b32 v4, v61
    s_waitcnt lgkmcnt(0)
    v_cmp_gt_u32 vcc, 0x80, v4
    s_cbranch_vccz Lg_31
    s_sub_u32 s87, s87, 1
    s_cbranch_scc0 Lf_30
Lg_31:
Lld_32:
    s_add_u32 m0, s9, 0
    s_add_u32 s5, s9, s10
    s_and_b32 s5, s5, 0xffff
    s_add_u32 s5, s5, s8
    s_add_u32 s9, s9, 4096
    buffer_load_dwordx4 v40, s[60:63], s5 offen offset:0 nt lds
    s_waitcnt vmcnt(31)
    buffer_load_dwordx4 v41, s[60:63], s5 offen offset:1024 nt lds
    s_waitcnt vmcnt(31)
    buffer_load_dwordx4 v42, s[60:63], s5 offen offset:2048 nt lds
    s_waitcnt vmcnt(31)
    buffer_load_dwordx4 v43, s[60:63], s5 offen offset:3072 nt lds
    s_waitcnt vmcnt(31)
    s_cmp_lt_u32 s9, 65536
    s_cbranch_scc1 Lld_32
    ds_write_b32 v46, v48
    s_mov_b32 s9, 0
Lld_33:
    s_add_u32 m0, s9, 65536
    s_add_u32 s5, s9, s10
    s_and_b32 s5, s5, 0xffff
    s_add_u32 s5, s5, s8
    s_add_u32 s9, s9, 4096
    buffer_load_dwordx4 v44, s[64:67], s5 offen offset:0 nt lds
    s_waitcnt vmcnt(31)
    buffer_load_dwordx4 v45, s[64:67], s5 offen offset:1024 nt lds
    s_waitcnt vmcnt(31)
    buffer_load_dwordx4 v44, s[64:67], s5 offen offset:2048 nt lds
    s_waitcnt vmcnt(31)
    buffer_load_dwordx4 v45, s[64:67], s5 offen offset:3072 nt lds
    s_waitcnt vmcnt(31)
    s_cmp_lt_u32 s9, 32768
    s_cbranch_scc1 Lld_33
    ds_write_b32 v46, v60
    s_mul_i32 s12, s82, 147456
    s_mul_i32 s4, s80, 36864
    s_add_u32 s12, s12, s4
Lld_34:
    s_add_u32 m0, s9, 65536
    s_add_u32 s5, s9, s10
    s_and_b32 s5, s5, 0xffff
    s_add_u32 s5, s5, s8
    s_add_u32 s9, s9, 4096
    buffer_load_dwordx4 v44, s[64:67], s5 offen offset:0 nt lds
    s_waitcnt vmcnt(31)
    buffer_load_dwordx4 v45, s[64:67], s5 offen offset:1024 nt lds
    s_waitcnt vmcnt(31)
    buffer_load_dwordx4 v44, s[64:67], s5 offen offset:2048 nt lds
    s_waitcnt vmcnt(31)
    buffer_load_dwordx4 v45, s[64:67], s5 offen offset:3072 nt lds
    s_waitcnt vmcnt(31)
    s_cmp_lt_u32 s9, 49152
    s_cbranch_scc1 Lld_34
    s_mov_b32 s11, 143360
Lwh_35:
    s_mov_b32 m0, s11
    s_add_u32 s11, s11, 1024
    buffer_load_dwordx4 v50, s[56:59], s12 offen nt lds
    s_waitcnt vmcnt(31)
    s_mov_b32 m0, s11
    s_add_u32 s11, s11, 1024
    buffer_load_dwordx4 v51, s[56:59], s12 offen nt lds
    s_waitcnt vmcnt(31)
    s_mov_b32 m0, s11
    s_add_u32 s11, s11, 1024
    buffer_load_dwordx4 v52, s[56:59], s12 offen nt lds
    s_waitcnt vmcnt(31)
    s_mov_b32 m0, s11
    s_add_u32 s11, s11, 1024
    buffer_load_dwordx4 v53, s[56:59], s12 offen nt lds
    s_waitcnt vmcnt(31)
    s_mov_b32 m0, s11
    s_add_u32 s11, s11, 1024
    buffer_load_dwordx4 v54, s[56:59], s12 offen nt lds
    s_waitcnt vmcnt(31)
    s_mov_b32 m0, s11
    s_add_u32 s11, s11, 1024
    buffer_load_dwordx4 v55, s[56:59], s12 offen nt lds
    s_waitcnt vmcnt(31)
    s_mov_b32 m0, s11
    s_add_u32 s11, s11, 1024
    buffer_load_dwordx4 v56, s[56:59], s12 offen nt lds
    s_waitcnt vmcnt(31)
    s_mov_b32 m0, s11
    s_add_u32 s11, s11, 1024
    buffer_load_dwordx4 v57, s[56:59], s12 offen nt lds
    s_waitcnt vmcnt(31)
    s_mov_b32 m0, s11
    s_add_u32 s11, s11, 1024
    buffer_load_dwordx4 v58, s[56:59], s12 offen nt lds
    s_waitcnt vmcnt(31)
    s_add_u32 s12, s12, 9216
    s_cmp_lt_u32 s11, 161792
    s_cbranch_scc1 Lwh_35
Lld_36:
    s_add_u32 m0, s9, 65536
    s_add_u32 s5, s9, s10
    s_and_b32 s5, s5, 0xffff
    s_add_u32 s5, s5, s8
    s_add_u32 s9, s9, 4096
    buffer_load_dwordx4 v44, s[64:67], s5 offen offset:0 nt lds
    s_waitcnt vmcnt(31)
    buffer_load_dwordx4 v45, s[64:67], s5 offen offset:1024 nt lds
    s_waitcnt vmcnt(31)
    buffer_load_dwordx4 v44, s[64:67], s5 offen offset:2048 nt lds
    s_waitcnt vmcnt(31)
    buffer_load_dwordx4 v45, s[64:67], s5 offen offset:3072 nt lds
    s_waitcnt vmcnt(31)
    s_cmp_lt_u32 s9, 65536
    s_cbranch_scc1 Lld_36
    s_mov_b32 s87, 1048576
Lf_37:
    ds_read_b32 v4, v59
    s_waitcnt lgkmcnt(0)
    v_cmp_gt_u32 vcc, 0x80, v4
    s_cbranch_vccz Lg_38
    s_sub_u32 s87, s87, 1
    s_cbranch_scc0 Lf_37
Lg_38:
    s_load_dwordx4 s[92:95], s[40:41], s90
    s_waitcnt lgkmcnt(0)
    s_mov_b32 s85, 1
    s_cmp_eq_u64 s[92:93], s[100:101]
    s_cselect_b32 s85, s85, 0
    s_cmp_eq_u64 s[94:95], s[100:101]
    s_cselect_b32 s85, s85, 0
    s_cmp_eq_u32 s85, 1
    s_cbranch_scc1 Lgl_39
    v_and_b32 v4, 3, v1
    v_lshl_add_u32 v4, v4, 2, s90
    global_load_dword v4, v4, s[40:41] sc1
    s_waitcnt vmcnt(0)
    v_cmp_ne_u32 vcc, s100, v4
    s_nop 0
    s_cmp_eq_u64 vcc, 0
    s_cselect_b32 s85, 1, 0
Lgl_39:
    v_xor_b32 v50, 64, v50
    v_xor_b32 v51, 64, v51
    v_xor_b32 v52, 64, v52
    v_xor_b32 v53, 64, v53
    v_xor_b32 v54, 64, v54
    v_xor_b32 v55, 64, v55
    v_xor_b32 v56, 64, v56
    v_xor_b32 v57, 64, v57
    v_xor_b32 v58, 64, v58
    s_mov_b32 s11, 0
Lwh_40:
    s_mov_b32 m0, s11
    s_add_u32 s11, s11, 1024
    buffer_load_dwordx4 v50, s[56:59], s12 offen nt lds
    s_waitcnt vmcnt(31)
    s_mov_b32 m0, s11
    s_add_u32 s11, s11, 1024
    buffer_load_dwordx4 v51, s[56:59], s12 offen nt lds
    s_waitcnt vmcnt(31)
    s_mov_b32 m0, s11
    s_add_u32 s11, s11, 1024
    buffer_load_dwordx4 v52, s[56:59], s12 offen nt lds
    s_waitcnt vmcnt(31)
    s_mov_b32 m0, s11
    s_add_u32 s11, s11, 1024
    buffer_load_dwordx4 v53, s[56:59], s12 offen nt lds
    s_waitcnt vmcnt(31)
    s_mov_b32 m0, s11
    s_add_u32 s11, s11, 1024
    buffer_load_dwordx4 v54, s[56:59], s12 offen nt lds
    s_waitcnt vmcnt(31)
    s_mov_b32 m0, s11
    s_add_u32 s11, s11, 1024
    buffer_load_dwordx4 v55, s[56:59], s12 offen nt lds
    s_waitcnt vmcnt(31)
    s_mov_b32 m0, s11
    s_add_u32 s11, s11, 1024
    buffer_load_dwordx4 v56, s[56:59], s12 offen nt lds
    s_waitcnt vmcnt(31)
    s_mov_b32 m0, s11
    s_add_u32 s11, s11, 1024
    buffer_load_dwordx4 v57, s[56:59], s12 offen nt lds
    s_waitcnt vmcnt(31)
    s_mov_b32 m0, s11
    s_add_u32 s11, s11, 1024
    buffer_load_dwordx4 v58, s[56:59], s12 offen nt lds
    s_waitcnt vmcnt(31)
    s_add_u32 s12, s12, 9216
    s_cmp_lt_u32 s11, 18432
    s_cbranch_scc1 Lwh_40
    s_waitcnt vmcnt(18)
L_B3:
    s_barrier
L_B3b:
    ds_read_b128 v[40:43], v219 offset:0
    ds_read_b64_tr_b16 v[112:113], v208 offset:0
    ds_read_b64_tr_b16 v[114:115], v208 offset:4096
    ds_read_b64_tr_b16 v[116:117], v209 offset:0
    ds_read_b64_tr_b16 v[118:119], v209 offset:4096
    ds_read_b128 v[44:47], v219 offset:64
    ds_read_b64_tr_b16 v[120:121], v208 offset:8192
    ds_read_b64_tr_b16 v[122:123], v208 offset:12288
    ds_read_b64_tr_b16 v[124:125], v209 offset:8192
    ds_read_b64_tr_b16 v[126:127], v209 offset:12288
    ds_read_b128 v[48:51], v219 offset:128
    ds_read_b64_tr_b16 v[128:129], v208 offset:16384
    ds_read_b64_tr_b16 v[130:131], v208 offset:20480
    ds_read_b64_tr_b16 v[132:133], v209 offset:16384
    ds_read_b64_tr_b16 v[134:135], v209 offset:20480
    ds_read_b128 v[52:55], v219 offset:192
    ds_read_b64_tr_b16 v[136:137], v208 offset:24576
    ds_read_b64_tr_b16 v[138:139], v208 offset:28672
    ds_read_b64_tr_b16 v[140:141], v209 offset:24576
    ds_read_b64_tr_b16 v[142:143], v209 offset:28672
    s_waitcnt lgkmcnt(15)
    v_mfma_f32_16x16x32_bf16 v[56:59], v[40:43], v[112:115], 0
    v_mfma_f32_16x16x32_bf16 v[60:63], v[40:43], v[116:119], 0
    s_waitcnt lgkmcnt(10)
    v_mfma_f32_16x16x32_bf16 v[56:59], v[44:47], v[120:123], v[56:59]
    v_mfma_f32_16x16x32_bf16 v[60:63], v[44:47], v[124:127], v[60:63]
    s_waitcnt lgkmcnt(5)
    v_mfma_f32_16x16x32_bf16 v[56:59], v[48:51], v[128:131], v[56:59]
    v_mfma_f32_16x16x32_bf16 v[60:63], v[48:51], v[132:135], v[60:63]
    s_waitcnt lgkmcnt(0)
    v_mfma_f32_16x16x32_bf16 v[56:59], v[52:55], v[136:139], v[56:59]
    v_mfma_f32_16x16x32_bf16 v[60:63], v[52:55], v[140:143], v[60:63]
    s_mov_b32 exec_hi, 0
    s_nop 5
    v_add_u32 v56, 0x10000, v56
    v_add_u32 v60, 0x10000, v60
    v_perm_b32 v88, v60, v56, v253
    v_bfi_b32 v88, v11, s79, v88
    s_cmp_eq_u32 s85, 1
    s_cbranch_scc1 Ls_41
    buffer_store_dword v88, v220, s[44:47], 0 offen sc1
    s_branch Ls_42
Ls_41:
    buffer_store_dword v88, v220, s[44:47], 0 offen
Ls_42:
    s_mov_b64 exec, -1
    s_mov_b32 s87, 262144
Lp_43:
    buffer_load_dwordx4 v[48:51], v237, s[44:47], 0 offen sc1
    buffer_load_dwordx4 v[40:43], v241, s[44:47], 0 offen sc1
    s_waitcnt vmcnt(0)
    v_bitop3_b32 v36, v50, v51, s77 bitop3:0x7e
    v_cmp_ne_u32 vcc, 0, v36
    s_cbranch_vccz Ld_44
    s_sub_u32 s87, s87, 1
    s_cbranch_scc0 Lp_43
Ld_44:
    s_barrier
    ds_read_b64_tr_b16 v[112:113], v239 offset:0
    ds_read_b64_tr_b16 v[114:115], v239 offset:2304
    ds_read_b64_tr_b16 v[116:117], v239 offset:256
    ds_read_b64_tr_b16 v[118:119], v239 offset:2560
    ds_read_b64_tr_b16 v[120:121], v239 offset:512
    ds_read_b64_tr_b16 v[122:123], v239 offset:2816
    ds_read_b64_tr_b16 v[124:125], v239 offset:768
    ds_read_b64_tr_b16 v[126:127], v239 offset:3072
    ds_read_b64_tr_b16 v[128:129], v240
    ds_read_b64_tr_b16 v[130:131], v240 offset:2304
    v_mov_b32 v53, v48
    s_nop 1
    v_max_f32_dpp v53, v53, v53 row_ror:2 row_mask:0xf bank_mask:0xf
    s_nop 1
    v_max_f32_dpp v53, v53, v53 row_ror:1 row_mask:0xf bank_mask:0xf
    v_mov_b32 v54, v53
    s_nop 1
    v_permlane16_swap_b32 v53, v54
    v_max_f32 v53, v53, v54
    v_mov_b32 v54, v53
    s_nop 1
    v_permlane32_swap_b32 v53, v54
    v_max_f32 v53, v53, v54
    v_sub_f32 v52, v48, v53
    v_exp_f32 v52, v52
    s_nop 0
    v_mul_f32 v53, v52, v49
    s_nop 1
    v_add_f32_dpp v53, v53, v53 row_ror:2 row_mask:0xf bank_mask:0xf
    s_nop 1
    v_add_f32_dpp v53, v53, v53 row_ror:1 row_mask:0xf bank_mask:0xf
    v_mov_b32 v54, v53
    s_nop 1
    v_permlane16_swap_b32 v53, v54
    v_add_f32 v53, v53, v54
    v_mov_b32 v54, v53
    s_nop 1
    v_permlane32_swap_b32 v53, v54
    v_add_f32 v53, v53, v54
    v_rcp_f32 v53, v53
    s_nop 0
    v_mul_f32 v52, v52, v53
    s_nop 1
    v_mov_b32_dpp v55, v52 row_newbcast:3 row_mask:0xf bank_mask:0xf
    v_mov_b32_dpp v54, v52 row_newbcast:2 row_mask:0xf bank_mask:0xf
    v_mov_b32_dpp v53, v52 row_newbcast:1 row_mask:0xf bank_mask:0xf
    v_mov_b32_dpp v52, v52 row_newbcast:0 row_mask:0xf bank_mask:0xf
    s_mov_b32 s87, 262144
    s_branch Lq_48
Lp_46:
    buffer_load_dwordx4 v[40:43], v241, s[44:47], 0 offen sc1
Lq_48:
    s_waitcnt vmcnt(0)
    v_bitop3_b32 v32, v40, v41, s79 bitop3:0x7e
    v_bitop3_b32 v33, v42, v43, s79 bitop3:0x7e
    v_or_b32 v32, v32, v33
    v_and_b32 v32, v11, v32
    v_cmp_ne_u32 vcc, 0, v32
    s_cbranch_vccz Ld_47
    s_sub_u32 s87, s87, 1
    s_cbranch_scc0 Lp_46
Ld_47:
    v_bfi_b32 v40, v11, 0, v40
    v_bfi_b32 v41, v11, 0, v41
    v_bfi_b32 v42, v11, 0, v42
    v_bfi_b32 v43, v11, 0, v43
    s_waitcnt lgkmcnt(0)
    s_nop 0
    v_mfma_f32_16x16x32_bf16 v[56:59], v[40:43], v[112:115], 0
    v_mfma_f32_16x16x32_bf16 v[60:63], v[40:43], v[116:119], 0
    v_mfma_f32_16x16x32_bf16 v[64:67], v[40:43], v[120:123], 0
    v_mfma_f32_16x16x32_bf16 v[68:71], v[40:43], v[124:127], 0
    v_mfma_f32_16x16x32_bf16 v[72:75], v[40:43], v[128:131], 0
    s_nop 3
    v_mul_f32 v88, v52, v56
    v_fmac_f32 v88, v53, v57
    v_fmac_f32 v88, v54, v58
    v_fmac_f32 v88, v55, v59
    v_mul_f32 v89, v52, v60
    v_fmac_f32 v89, v53, v61
    v_fmac_f32 v89, v54, v62
    v_fmac_f32 v89, v55, v63
    v_mul_f32 v90, v52, v64
    v_fmac_f32 v90, v53, v65
    v_fmac_f32 v90, v54, v66
    v_fmac_f32 v90, v55, v67
    v_mul_f32 v91, v52, v68
    v_fmac_f32 v91, v53, v69
    v_fmac_f32 v91, v54, v70
    v_fmac_f32 v91, v55, v71
    v_mul_f32 v92, v52, v72
    v_fmac_f32 v92, v53, v73
    v_fmac_f32 v92, v54, v74
    v_fmac_f32 v92, v55, v75
    v_permlane32_swap_b32 v88, v90
    v_permlane32_swap_b32 v89, v91
    v_mov_b32 v4, v92
    v_add_f32 v88, v88, v90
    v_add_f32 v89, v89, v91
    v_permlane32_swap_b32 v92, v4
    v_add_f32 v92, v92, v4
    v_permlane16_swap_b32 v88, v89
    v_mov_b32 v4, v92
    v_add_f32 v88, v88, v89
    v_bfi_b32 v88, v10, s77, v88
    buffer_store_dword v88, v242, s[44:47], 0 offen sc1
    v_permlane16_swap_b32 v92, v4
    v_add_f32 v92, v92, v4
    v_bfi_b32 v92, v10, s77, v92
    s_cmp_ge_u32 s3, 4
    s_cbranch_scc1 L_finB
    s_mov_b64 exec, 0xffff
    buffer_store_dword v92, v243, s[44:47], 0 offen sc1
    s_branch L_exit
L_finB:
    s_cmp_lt_u32 s86, 36
    s_cbranch_scc0 L_exit
    s_lshl_b32 s8, s86, 5
    s_add_u32 s8, s8, 1152
    s_lshl_b32 s4, s86, 13
    s_and_b32 s5, s3, 3
    s_lshl_b32 s6, s5, 11
    s_add_u32 s4, s4, s6
    s_add_u32 s4, s4, 5537792
    v_lshlrev_b32 v22, 4, v1
    v_lshlrev_b32 v21, 3, v2
    v_lshl_add_u32 v21, v3, 1, v21
    s_lshl_b32 s5, s5, 2
    s_add_u32 s5, s5, 139264
    v_lshl_add_u32 v23, v1, 4, s5
    v_add_u32 v20, 139264, v22
    s_mov_b32 s72, s38
    s_mov_b32 s73, s39
    s_mov_b32 s74, 2304
    s_mov_b32 s75, 0x20000
    s_mov_b32 s87, 262144
Lp_49:
    buffer_load_dwordx4 v[40:43], v22, s[44:47], s4 offen offset:0 sc1
    buffer_load_dwordx4 v[44:47], v22, s[44:47], s4 offen offset:1024 sc1
    s_waitcnt vmcnt(0)
    v_bitop3_b32 v72, v40, v41, s77 bitop3:0x7e
    v_bitop3_b32 v73, v42, v43, s77 bitop3:0x7e
    v_bitop3_b32 v74, v44, v45, s77 bitop3:0x7e
    v_bitop3_b32 v75, v46, v47, s77 bitop3:0x7e
    v_or3_b32 v72, v72, v73, v74
    v_or_b32 v72, v72, v75
    v_and_b32 v72, v10, v72
    v_cmp_ne_u32 vcc, 0, v72
    s_cbranch_vccz Ld_50
    s_sub_u32 s87, s87, 1
    s_cbranch_scc0 Lp_49
Ld_50:
    v_bfi_b32 v40, v10, 0, v40
    v_bfi_b32 v41, v10, 0, v41
    v_bfi_b32 v42, v10, 0, v42
    v_bfi_b32 v43, v10, 0, v43
    v_bfi_b32 v44, v10, 0, v44
    v_bfi_b32 v45, v10, 0, v45
    v_bfi_b32 v46, v10, 0, v46
    v_bfi_b32 v47, v10, 0, v47
    v_add_f32 v40, v40, v44
    v_add_f32 v41, v41, v45
    v_add_f32 v42, v42, v46
    v_add_f32 v43, v43, v47
    s_nop 0
    v_permlane32_swap_b32 v40, v42
    v_permlane32_swap_b32 v41, v43
    v_add_f32 v40, v40, v42
    v_add_f32 v41, v41, v43
    s_nop 1
    v_permlane16_swap_b32 v40, v41
    v_add_f32 v40, v40, v41
    s_nop 1
    v_add_f32_dpp v40, v40, v40 row_ror:8 row_mask:0xf bank_mask:0xf
    s_nop 1
    v_add_f32_dpp v40, v40, v40 row_ror:4 row_mask:0xf bank_mask:0xf
    ds_write_b32 v23, v40
    s_waitcnt lgkmcnt(0)
    s_barrier
    s_cmp_eq_u32 s3, 4
    s_cbranch_scc0 L_exit
    ds_read_b128 v[40:43], v20
    s_waitcnt lgkmcnt(0)
    v_add_f32 v40, v40, v41
    v_add_f32 v42, v42, v43
    v_add_f32 v40, v40, v42
    v_cvt_pk_bf16_f32 v40, v40, v40
    s_mov_b32 exec_lo, 0xf000f
    s_mov_b32 exec_hi, 0xf000f
    buffer_store_short v40, v21, s[72:75], s8 offen
    s_cmp_eq_u32 s86, 0
    s_cbranch_scc0 L_exit
    s_mov_b64 exec, 1
    v_mov_b32 v41, s77
    v_mov_b32 v42, 0
    buffer_store_dword v41, v42, s[44:47], 0 offen offset:4 sc1
    s_branch L_exit
L_Sidle:
    s_waitcnt lgkmcnt(0)
    s_mov_b64 s[44:45], s[42:43]
    s_load_dwordx2 s[76:77], s[42:43], 0
    s_mov_b64 s[68:69], s[24:25]
    s_mov_b64 s[56:57], s[26:27]
    s_cmp_eq_u32 s3, 5
    s_cbranch_scc0 Lip_52
    s_getpc_b64 s[4:5]
Lpc_53:
    s_add_u32 s4, s4, L_A2-Lpc_53
    s_addc_u32 s5, s5, -1
    s_cmp_ge_i32 L_A2-Lpc_53, 0
    s_cselect_b32 s6, 1, 0
    s_add_u32 s5, s5, s6
    s_mov_b32 s6, L_exit0-L_A2
    s_mov_b32 s7, 0x20000
    s_lshr_b32 s12, s86, 3
    s_lshl_b32 s12, s12, 10
    v_lshlrev_b32 v4, 4, v1
    buffer_load_dwordx4 v[40:43], v4, s[4:7], s12 offen
    s_waitcnt vmcnt(0)
Lip_52:
    s_call_b64 s[16:17], L_aaddr
    s_waitcnt lgkmcnt(0)
    s_add_u32 s76, s76, 1
    s_and_b32 s12, s76, 2
    s_lshl_b32 s12, s12, 15
    s_and_b32 s78, s76, 1
    s_or_b32 s78, s78, s12
    s_add_u32 s77, s77, 1
    s_and_b32 s12, s77, 2
    s_lshl_b32 s12, s12, 15
    s_and_b32 s79, s77, 1
    s_or_b32 s79, s79, s12
    s_branch L_A2
L_aaddr:
    v_xor_b32 v4, v3, v2
    v_lshlrev_b32 v4, 4, v4
    s_lshl_b32 s4, s3, 14
    v_lshl_add_u32 v5, v2, 10, s4
    v_add_u32 v200, v5, v4
    v_xor_b32 v201, 64, v200
    v_xor_b32 v202, 0x80, v200
    v_xor_b32 v203, 0xc0, v200
    v_lshlrev_b32 v5, 10, v2
    v_add_u32 v5, 131072, v5
    v_add_u32 v204, v5, v4
    v_xor_b32 v205, 64, v204
    v_xor_b32 v206, 0x80, v204
    v_xor_b32 v207, 0xc0, v204
    v_lshrrev_b32 v4, 2, v2
    v_lshlrev_b32 v4, 1, v4
    v_lshl_add_u32 v5, v3, 3, v4
    v_lshlrev_b32 v5, 10, v5
    v_xor_b32 v6, s3, v3
    v_and_b32 v6, 1, v6
    v_lshl_add_u32 v6, v6, 3, v4
    v_bfe_u32 v7, v2, 1, 1
    v_add_u32 v6, v6, v7
    v_lshl_add_u32 v5, v6, 4, v5
    v_and_b32 v7, 1, v2
    v_lshl_add_u32 v5, v7, 3, v5
    s_lshr_b32 s4, s3, 1
    s_lshl_b32 s4, s4, 8
    v_add_u32 v208, s4, v5
    v_xor_b32 v209, 16, v208
    v_xor_b32 v210, 32, v208
    v_xor_b32 v211, 48, v208
    v_xor_b32 v212, 64, v208
    v_xor_b32 v213, 80, v208
    v_xor_b32 v214, 96, v208
    v_xor_b32 v215, 112, v208
    v_mul_u32_u24 v4, 272, v2
    v_lshl_add_u32 v219, v3, 4, v4
    v_add_u32 v219, 147968, v219
    v_lshrrev_b32 v5, 1, v3
    v_lshl_add_u32 v4, v5, 4, v4
    v_and_b32 v5, 1, v3
    v_lshl_add_u32 v4, v5, 2, v4
    s_lshl_b32 s4, s3, 5
    s_add_u32 s4, s4, 147968
    v_add_u32 v216, s4, v4
    v_lshlrev_b32 v4, 5, v2
    v_add_u32 v218, 147456, v4
    s_lshl_b32 s4, s3, 2
    v_add_u32 v217, s4, v218
    s_lshl_b32 s4, s84, 20
    s_lshl_b32 s5, s3, 13
    s_add_u32 s4, s4, s5
    s_lshl_b32 s5, s83, 7
    s_add_u32 s4, s4, s5
    s_add_u32 s4, s4, 1048576
    v_and_b32 v4, 7, v2
    v_lshlrev_b32 v4, 16, v4
    v_lshl_add_u32 v4, v3, 4, v4
    v_lshrrev_b32 v5, 3, v2
    v_lshl_add_u32 v4, v5, 6, v4
    v_add_u32 v220, s4, v4
    s_lshl_b32 s4, s84, 16
    s_and_b32 s5, s83, 7
    s_lshl_b32 s5, s5, 7
    s_add_u32 s4, s4, s5
    s_lshr_b32 s5, s83, 3
    s_lshl_b32 s5, s5, 4
    s_add_u32 s4, s4, s5
    s_add_u32 s4, s4, 262144
    v_lshl_add_u32 v221, v2, 12, s4
    v_lshl_add_u32 v221, v3, 10, v221
    s_and_b32 s4, s3, 1
    s_lshl_b32 s4, s4, 3
    v_lshl_add_u32 v4, v3, 1, s4
    v_xor_b32 v4, v4, v2
    v_lshlrev_b32 v4, 4, v4
    v_lshl_add_u32 v222, v3, 13, v4
    s_lshl_b32 s4, s3, 6
    s_add_u32 s4, s4, -64
    v_add_u32 v9, s4, v1
    v_mul_u32_u24 v4, 14564, v9
    v_lshrrev_b32 v4, 20, v4
    v_mul_u32_u24 v5, 72, v4
    v_sub_u32 v5, v9, v5
    v_lshrrev_b32 v223, 1, v4
    v_and_b32 v223, 2, v223
    v_xor_b32 v5, v5, v223
    v_lshrrev_b32 v223, 2, v4
    v_and_b32 v223, 4, v223
    v_xor_b32 v5, v5, v223
    v_mul_u32_u24 v4, 1152, v4
    v_lshl_add_u32 v223, v5, 4, v4
    s_lshl_b32 s4, s3, 6
    s_add_u32 s4, s4, 384
    v_add_u32 v9, s4, v1
    v_mul_u32_u24 v4, 14564, v9
    v_lshrrev_b32 v4, 20, v4
    v_mul_u32_u24 v5, 72, v4
    v_sub_u32 v5, v9, v5
    v_lshrrev_b32 v224, 1, v4
    v_and_b32 v224, 2, v224
    v_xor_b32 v5, v5, v224
    v_lshrrev_b32 v224, 2, v4
    v_and_b32 v224, 4, v224
    v_xor_b32 v5, v5, v224
    v_mul_u32_u24 v4, 1152, v4
    v_lshl_add_u32 v224, v5, 4, v4
    s_lshl_b32 s4, s3, 6
    s_add_u32 s4, s4, 832
    v_add_u32 v9, s4, v1
    v_mul_u32_u24 v4, 14564, v9
    v_lshrrev_b32 v4, 20, v4
    v_mul_u32_u24 v5, 72, v4
    v_sub_u32 v5, v9, v5
    v_lshrrev_b32 v225, 1, v4
    v_and_b32 v225, 2, v225
    v_xor_b32 v5, v5, v225
    v_lshrrev_b32 v225, 2, v4
    v_and_b32 v225, 4, v225
    v_xor_b32 v5, v5, v225
    v_mul_u32_u24 v4, 1152, v4
    v_lshl_add_u32 v225, v5, 4, v4
    s_lshl_b32 s4, s3, 6
    s_add_u32 s4, s4, 1280
    v_add_u32 v9, s4, v1
    v_mul_u32_u24 v4, 14564, v9
    v_lshrrev_b32 v4, 20, v4
    v_mul_u32_u24 v5, 72, v4
    v_sub_u32 v5, v9, v5
    v_lshrrev_b32 v226, 1, v4
    v_and_b32 v226, 2, v226
    v_xor_b32 v5, v5, v226
    v_lshrrev_b32 v226, 2, v4
    v_and_b32 v226, 4, v226
    v_xor_b32 v5, v5, v226
    v_mul_u32_u24 v4, 1152, v4
    v_lshl_add_u32 v226, v5, 4, v4
    s_lshl_b32 s4, s3, 6
    s_add_u32 s4, s4, 1728
    v_add_u32 v9, s4, v1
    v_mul_u32_u24 v4, 14564, v9
    v_lshrrev_b32 v4, 20, v4
    v_mul_u32_u24 v5, 72, v4
    v_sub_u32 v5, v9, v5
    v_lshrrev_b32 v227, 1, v4
    v_and_b32 v227, 2, v227
    v_xor_b32 v5, v5, v227
    v_lshrrev_b32 v227, 2, v4
    v_and_b32 v227, 4, v227
    v_xor_b32 v5, v5, v227
    v_mul_u32_u24 v4, 1152, v4
    v_lshl_add_u32 v227, v5, 4, v4
    s_lshl_b32 s4, s3, 6
    s_add_u32 s4, s4, 2176
    v_add_u32 v9, s4, v1
    v_mul_u32_u24 v4, 14564, v9
    v_lshrrev_b32 v4, 20, v4
    v_mul_u32_u24 v5, 72, v4
    v_sub_u32 v5, v9, v5
    v_lshrrev_b32 v246, 1, v4
    v_and_b32 v246, 2, v246
    v_xor_b32 v5, v5, v246
    v_lshrrev_b32 v246, 2, v4
    v_and_b32 v246, 4, v246
    v_xor_b32 v5, v5, v246
    v_mul_u32_u24 v4, 1152, v4
    v_lshl_add_u32 v246, v5, 4, v4
    v_lshrrev_b32 v4, 2, v2
    v_lshl_add_u32 v5, v3, 2, v4
    v_and_b32 v6, 7, v5
    v_lshlrev_b32 v6, 1, v6
    v_bfe_u32 v7, v2, 1, 1
    v_xor_b32 v6, v6, v7
    v_lshlrev_b32 v5, 8, v5
    v_lshl_add_u32 v5, v6, 4, v5
    v_and_b32 v7, 1, v2
    v_lshl_add_u32 v5, v7, 3, v5
    s_and_b32 s4, s3, 1
    s_lshl_b32 s4, s4, 14
    s_add_u32 s4, s4, 0
    v_add_u32 v228, s4, v5
    v_xor_b32 v229, 32, v228
    v_xor_b32 v230, 64, v228
    v_xor_b32 v231, 96, v228
    v_xor_b32 v232, 128, v228
    v_xor_b32 v233, 160, v228
    v_xor_b32 v234, 192, v228
    v_xor_b32 v235, 224, v228
    s_lshl_b32 s4, s81, 16
    s_lshl_b32 s5, s80, 14
    s_add_u32 s4, s4, s5
    s_and_b32 s5, s3, 1
    s_lshl_b32 s5, s5, 13
    s_add_u32 s4, s4, s5
    s_lshr_b32 s6, s3, 1
    s_lshl_b32 s5, s6, 11
    s_add_u32 s4, s4, s5
    s_add_u32 s4, s4, 1048576
    v_lshlrev_b32 v4, 7, v2
    v_lshl_add_u32 v4, v3, 4, v4
    v_add_u32 v236, s4, v4
    s_lshl_b32 s4, s6, 6
    s_add_u32 s4, s4, 152576
    v_lshl_add_u32 v244, v3, 4, s4
    v_and_b32 v4, 7, v1
    v_lshlrev_b32 v4, 5, v4
    v_lshrrev_b32 v5, 3, v1
    v_lshl_add_u32 v245, v5, 2, v4
    v_add_u32 v245, 152576, v245
    s_lshl_b32 s4, s81, 12
    s_lshl_b32 s5, s80, 10
    s_add_u32 s4, s4, s5
    s_add_u32 s4, s4, 262144
    v_lshl_add_u32 v237, v1, 4, s4
    s_lshl_b32 s4, s81, 13
    s_lshl_b32 s5, s80, 9
    s_add_u32 s4, s4, s5
    s_lshl_b32 s5, s3, 6
    s_add_u32 s4, s4, s5
    s_add_u32 s4, s4, 4194304
    v_lshlrev_b32 v4, 11, v3
    v_lshl_add_u32 v4, v2, 2, v4
    v_add_u32 v238, s4, v4
    s_lshl_b32 s74, s80, 20
    s_lshl_b32 s4, s81, 8
    s_add_u32 s74, s74, s4
    s_lshl_b32 s4, s3, 15
    s_add_u32 s74, s74, s4
    s_lshl_b32 s4, s3, 11
    s_add_u32 s4, s4, 131072
    v_and_b32 v4, 7, v2
    v_xor_b32 v4, v4, v3
    v_lshlrev_b32 v4, 4, v4
    v_lshl_add_u32 v4, v2, 7, v4
    v_add_u32 v247, s4, v4
    v_xor_b32 v248, 64, v247
    v_lshrrev_b32 v4, 3, v1
    v_and_b32 v5, 7, v1
    v_xor_b32 v6, v4, v5
    v_lshlrev_b32 v6, 4, v6
    v_lshl_add_u32 v250, v4, 7, v6
    v_add_u32 v249, s4, v250
    v_and_b32 v6, 3, v1
    v_lshlrev_b32 v6, 8, v6
    v_lshrrev_b32 v7, 2, v1
    v_lshl_add_u32 v6, v7, 4, v6
    s_lshl_b32 s4, s3, 10
    s_add_u32 s4, s4, 153600
    v_add_u32 v251, s4, v6
    v_lshlrev_b32 v252, 4, v1
    v_add_u32 v252, 153600, v252
    s_lshl_b32 s4, s84, 20
    s_lshl_b32 s5, s3, 13
    s_add_u32 s4, s4, s5
    s_lshl_b32 s5, s83, 7
    s_add_u32 s4, s4, s5
    s_add_u32 s4, s4, 1048576
    v_lshlrev_b32 v4, 16, v4
    v_lshl_add_u32 v4, v5, 4, v4
    v_add_u32 v220, s4, v4
    s_lshl_b32 s4, s81, 16
    s_lshl_b32 s5, s80, 14
    s_add_u32 s4, s4, s5
    s_and_b32 s5, s3, 1
    s_lshl_b32 s5, s5, 13
    s_add_u32 s4, s4, s5
    s_lshr_b32 s5, s3, 1
    s_lshl_b32 s5, s5, 11
    s_add_u32 s4, s4, s5
    s_add_u32 s4, s4, 1048576
    v_add_u32 v236, s4, v250
    v_lshrrev_b32 v4, 2, v2
    v_and_b32 v5, 1, v4
    v_lshrrev_b32 v6, 1, v4
    v_lshl_add_u32 v6, v3, 2, v6
    v_lshl_add_u32 v6, v5, 4, v6
    v_mul_u32_u24 v6, 1152, v6
    v_mul_i32_i24 v7, 0, v5
    v_add_u32 v6, v6, v7
    v_and_b32 v7, 1, v3
    v_lshl_or_b32 v7, v5, 1, v7
    v_lshlrev_b32 v7, 1, v7
    v_bfe_u32 v8, v2, 1, 1
    v_xor_b32 v7, v7, v8
    s_and_b32 s4, s3, 3
    s_lshl_b32 s4, s4, 1
    v_xor_b32 v7, s4, v7
    v_lshl_add_u32 v6, v7, 4, v6
    v_and_b32 v8, 1, v2
    v_lshl_add_u32 v6, v8, 3, v6
    v_add_u32 v240, 33792, v6
    s_lshr_b32 s4, s3, 2
    s_lshl_b32 s4, s4, 7
    s_add_u32 s4, s4, 32768
    v_add_u32 v239, s4, v6
    s_lshl_b32 s4, s81, 2
    s_add_u32 s4, s4, s80
    s_mul_i32 s4, s4, 2048
    s_add_u32 s4, s4, 4194304
    v_lshlrev_b32 v241, 6, v2
    v_lshl_add_u32 v241, v3, 4, v241
    v_add_u32 v241, s4, v241
    s_lshl_b32 s4, s86, 6
    s_add_u32 s4, s4, 5242880
    s_lshl_b32 s5, s3, 13
    s_add_u32 s5, s5, s4
    v_lshlrev_b32 v242, 16, v3
    v_lshl_add_u32 v242, v2, 2, v242
    v_add_u32 v242, s5, v242
    s_and_b32 s5, s3, 3
    s_add_u32 s5, s5, 32
    s_lshl_b32 s5, s5, 13
    s_add_u32 s5, s5, s4
    v_lshlrev_b32 v243, 2, v2
    v_add_u32 v243, s5, v243
    s_lshl_b32 s4, s81, 2
    s_add_u32 s4, s4, s80
    s_lshl_b32 s4, s4, 11
    s_add_u32 s4, s4, 4194304
    v_lshl_add_u32 v241, v1, 4, s4
    s_and_b32 s4, s3, 3
    s_lshl_b32 s5, s4, 12
    s_lshl_b32 s13, s84, 14
    s_add_u32 s13, s13, s5
    s_add_u32 s13, s13, 7340032
    v_lshlrev_b32 v22, 4, v1
    s_lshl_b32 s4, s4, 6
    v_xor_b32 v21, s4, v22
    s_add_u32 s5, s5, 131072
    v_add_u32 v21, s5, v21
    s_setpc_b64 s[16:17]
L_A2:
    s_barrier
    s_load_dwordx4 s[92:95], s[40:41], s90
    s_waitcnt lgkmcnt(0)
    s_mov_b32 s85, 1
    s_cmp_eq_u64 s[92:93], s[100:101]
    s_cselect_b32 s85, s85, 0
    s_cmp_eq_u64 s[94:95], s[100:101]
    s_cselect_b32 s85, s85, 0
    s_cmp_eq_u32 s85, 1
    s_cbranch_scc1 Lgl_54
    v_and_b32 v4, 3, v1
    v_lshl_add_u32 v4, v4, 2, s90
    global_load_dword v4, v4, s[40:41] sc1
    s_waitcnt vmcnt(0)
    v_cmp_ne_u32 vcc, s100, v4
    s_nop 0
    s_cmp_eq_u64 vcc, 0
    s_cselect_b32 s85, 1, 0
Lgl_54:
    v_mov_b32 v28, 0x3f803f80
    v_mov_b32 v29, 0x3f803f80
    v_mov_b32 v30, 0x3f803f80
    v_mov_b32 v31, 0x3f803f80
    s_mul_i32 s8, s81, 147456
    s_mul_i32 s4, s80, 36864
    s_add_u32 s8, s8, s4
    s_cmp_ge_u32 s3, 6
    s_cbranch_scc1 L_A2b
    ds_read_b128 v[40:43], v200 offset:0
    ds_read_b128 v[44:47], v201 offset:0
    ds_read_b128 v[48:51], v202 offset:0
    ds_read_b128 v[52:55], v203 offset:0
    ds_read_b128 v[56:59], v200 offset:256
    ds_read_b128 v[60:63], v201 offset:256
    ds_read_b128 v[64:67], v202 offset:256
    ds_read_b128 v[68:71], v203 offset:256
    ds_read_b128 v[72:75], v200 offset:512
    ds_read_b128 v[76:79], v201 offset:512
    ds_read_b128 v[80:83], v202 offset:512
    ds_read_b128 v[84:87], v203 offset:512
    ds_read_b128 v[88:91], v200 offset:768
    ds_read_b128 v[92:95], v201 offset:768
    ds_read_b128 v[96:99], v202 offset:768
    ds_read_b128 v[100:103], v203 offset:768
L_A2b:
    ds_read_b64_tr_b16 v[112:113], v208 offset:0
    ds_read_b64_tr_b16 v[114:115], v209 offset:1024
    ds_read_b64_tr_b16 v[116:117], v210 offset:0
    ds_read_b64_tr_b16 v[118:119], v211 offset:1024
    ds_read_b64_tr_b16 v[120:121], v212 offset:0
    ds_read_b64_tr_b16 v[122:123], v213 offset:1024
    ds_read_b64_tr_b16 v[124:125], v214 offset:0
    ds_read_b64_tr_b16 v[126:127], v215 offset:1024
    ds_read_b64_tr_b16 v[128:129], v208 offset:32768
    ds_read_b64_tr_b16 v[130:131], v209 offset:33792
    ds_read_b64_tr_b16 v[132:133], v210 offset:32768
    ds_read_b64_tr_b16 v[134:135], v211 offset:33792
    ds_read_b64_tr_b16 v[136:137], v212 offset:32768
    ds_read_b64_tr_b16 v[138:139], v213 offset:33792
    ds_read_b64_tr_b16 v[140:141], v214 offset:32768
    ds_read_b64_tr_b16 v[142:143], v215 offset:33792
    v_add_u32 v208, 0x10000, v208
    v_add_u32 v209, 0x10000, v209
    v_add_u32 v210, 0x10000, v210
    v_add_u32 v211, 0x10000, v211
    v_add_u32 v212, 0x10000, v212
    v_add_u32 v213, 0x10000, v213
    v_add_u32 v214, 0x10000, v214
    v_add_u32 v215, 0x10000, v215
    ds_read_b64_tr_b16 v[144:145], v208 offset:0
    ds_read_b64_tr_b16 v[146:147], v209 offset:1024
    ds_read_b64_tr_b16 v[148:149], v210 offset:0
    ds_read_b64_tr_b16 v[150:151], v211 offset:1024
    ds_read_b64_tr_b16 v[152:153], v212 offset:0
    ds_read_b64_tr_b16 v[154:155], v213 offset:1024
    ds_read_b64_tr_b16 v[156:157], v214 offset:0
    ds_read_b64_tr_b16 v[158:159], v215 offset:1024
    s_waitcnt lgkmcnt(0)
    s_barrier
    s_lshl_b32 s4, s3, 10
    s_add_u32 m0, s4, 0
    s_add_u32 s5, s74, 0
    buffer_load_dwordx4 v222, s[68:71], s5 offen nt lds
    s_lshl_b32 s4, s3, 10
    s_add_u32 m0, s4, 8192
    s_add_u32 s5, s74, 262144
    buffer_load_dwordx4 v222, s[68:71], s5 offen nt lds
    s_waitcnt vmcnt(2)
    s_barrier
    s_cmp_lt_u32 s3, 4
    s_cbranch_scc1 L_A2a
    buffer_load_dwordx4 v[176:179], v22, s[44:47], s13 offen offset:0 sc1
    buffer_load_dwordx4 v[180:183], v22, s[44:47], s13 offen offset:1024 sc1
    buffer_load_dwordx4 v[184:187], v22, s[44:47], s13 offen offset:2048 sc1
    buffer_load_dwordx4 v[188:191], v22, s[44:47], s13 offen offset:3072 sc1
    s_cmp_lt_u32 s3, 6
    s_cbranch_scc1 L_A2a
    ds_read_b128 v[40:43], v200 offset:0
    ds_read_b128 v[44:47], v201 offset:0
    ds_read_b128 v[48:51], v202 offset:0
    ds_read_b128 v[52:55], v203 offset:0
    ds_read_b128 v[56:59], v200 offset:256
    ds_read_b128 v[60:63], v201 offset:256
    ds_read_b128 v[64:67], v202 offset:256
    ds_read_b128 v[68:71], v203 offset:256
    ds_read_b128 v[72:75], v200 offset:512
    ds_read_b128 v[76:79], v201 offset:512
    ds_read_b128 v[80:83], v202 offset:512
    ds_read_b128 v[84:87], v203 offset:512
    ds_read_b128 v[88:91], v200 offset:768
    ds_read_b128 v[92:95], v201 offset:768
    ds_read_b128 v[96:99], v202 offset:768
    ds_read_b128 v[100:103], v203 offset:768
L_A2a:
    ds_read_b64_tr_b16 v[160:161], v208 offset:32768
    ds_read_b64_tr_b16 v[162:163], v209 offset:33792
    ds_read_b64_tr_b16 v[164:165], v210 offset:32768
    ds_read_b64_tr_b16 v[166:167], v211 offset:33792
    ds_read_b64_tr_b16 v[168:169], v212 offset:32768
    ds_read_b64_tr_b16 v[170:171], v213 offset:33792
    ds_read_b64_tr_b16 v[172:173], v214 offset:32768
    ds_read_b64_tr_b16 v[174:175], v215 offset:33792
    s_cmp_lt_u32 s3, 4
    s_cbranch_scc1 L_A2c
    s_mov_b32 s87, 262144
    s_branch Lq_57
Lp_55:
    buffer_load_dwordx4 v[176:179], v22, s[44:47], s13 offen offset:0 sc1
    buffer_load_dwordx4 v[180:183], v22, s[44:47], s13 offen offset:1024 sc1
    buffer_load_dwordx4 v[184:187], v22, s[44:47], s13 offen offset:2048 sc1
    buffer_load_dwordx4 v[188:191], v22, s[44:47], s13 offen offset:3072 sc1
Lq_57:
    s_waitcnt vmcnt(0)
    v_bitop3_b32 v192, v176, v177, s78 bitop3:0x7e
    v_bitop3_b32 v193, v178, v179, s78 bitop3:0x7e
    v_bitop3_b32 v194, v180, v181, s78 bitop3:0x7e
    v_bitop3_b32 v195, v182, v183, s78 bitop3:0x7e
    v_bitop3_b32 v196, v184, v185, s78 bitop3:0x7e
    v_bitop3_b32 v197, v186, v187, s78 bitop3:0x7e
    v_bitop3_b32 v198, v188, v189, s78 bitop3:0x7e
    v_bitop3_b32 v199, v190, v191, s78 bitop3:0x7e
    v_or3_b32 v192, v192, v193, v194
    v_or3_b32 v195, v195, v196, v197
    v_or_b32 v198, v198, v199
    v_or3_b32 v192, v192, v195, v198
    v_and_b32 v192, v11, v192
    v_cmp_ne_u32 vcc, 0, v192
    s_cbranch_vccz Ld_56
    s_sub_u32 s87, s87, 1
    s_cbranch_scc0 Lp_55
Ld_56:
    v_bfi_b32 v176, v11, 0, v176
    v_bfi_b32 v177, v11, 0, v177
    v_bfi_b32 v178, v11, 0, v178
    v_bfi_b32 v179, v11, 0, v179
    v_xor_b32 v192, 0, v21
    ds_write_b128 v192, v[176:179] offset:0
    v_bfi_b32 v180, v11, 0, v180
    v_bfi_b32 v181, v11, 0, v181
    v_bfi_b32 v182, v11, 0, v182
    v_bfi_b32 v183, v11, 0, v183
    v_xor_b32 v193, 16, v21
    ds_write_b128 v193, v[180:183] offset:1024
    v_bfi_b32 v184, v11, 0, v184
    v_bfi_b32 v185, v11, 0, v185
    v_bfi_b32 v186, v11, 0, v186
    v_bfi_b32 v187, v11, 0, v187
    v_xor_b32 v194, 32, v21
    ds_write_b128 v194, v[184:187] offset:2048
    v_bfi_b32 v188, v11, 0, v188
    v_bfi_b32 v189, v11, 0, v189
    v_bfi_b32 v190, v11, 0, v190
    v_bfi_b32 v191, v11, 0, v191
    v_xor_b32 v195, 48, v21
    ds_write_b128 v195, v[188:191] offset:3072
L_A2c:
    s_waitcnt lgkmcnt(0)
    s_barrier
    ds_read_b128 v[176:179], v204 offset:0
    ds_read_b128 v[180:183], v205 offset:0
    ds_read_b128 v[184:187], v206 offset:0
    ds_read_b128 v[188:191], v207 offset:0
    ds_read_b128 v[192:195], v204 offset:256
    ds_read_b128 v[196:199], v205 offset:256
    s_waitcnt lgkmcnt(5)
    v_mfma_f32_16x16x32_bf16 v[104:107], v[40:43], v[176:179], 0
    ds_read_b128 v[176:179], v206 offset:256
    s_waitcnt lgkmcnt(5)
    v_mfma_f32_16x16x32_bf16 v[104:107], v[44:47], v[180:183], v[104:107]
    ds_read_b128 v[180:183], v207 offset:256
    s_waitcnt lgkmcnt(5)
    v_mfma_f32_16x16x32_bf16 v[104:107], v[48:51], v[184:187], v[104:107]
    ds_read_b128 v[184:187], v204 offset:512
    s_waitcnt lgkmcnt(5)
    v_mfma_f32_16x16x32_bf16 v[104:107], v[52:55], v[188:191], v[104:107]
    ds_read_b128 v[188:191], v205 offset:512
    s_waitcnt lgkmcnt(5)
    v_mfma_f32_16x16x32_bf16 v[104:107], v[56:59], v[192:195], v[104:107]
    ds_read_b128 v[192:195], v206 offset:512
    s_waitcnt lgkmcnt(5)
    v_mfma_f32_16x16x32_bf16 v[104:107], v[60:63], v[196:199], v[104:107]
    ds_read_b128 v[196:199], v207 offset:512
    s_waitcnt lgkmcnt(5)
    v_mfma_f32_16x16x32_bf16 v[104:107], v[64:67], v[176:179], v[104:107]
    ds_read_b128 v[176:179], v204 offset:768
    s_waitcnt lgkmcnt(5)
    v_mfma_f32_16x16x32_bf16 v[104:107], v[68:71], v[180:183], v[104:107]
    ds_read_b128 v[180:183], v205 offset:768
    s_waitcnt lgkmcnt(5)
    v_mfma_f32_16x16x32_bf16 v[104:107], v[72:75], v[184:187], v[104:107]
    ds_read_b128 v[184:187], v206 offset:768
    s_waitcnt lgkmcnt(5)
    v_mfma_f32_16x16x32_bf16 v[104:107], v[76:79], v[188:191], v[104:107]
    ds_read_b128 v[188:191], v207 offset:768
    s_waitcnt lgkmcnt(5)
    v_mfma_f32_16x16x32_bf16 v[104:107], v[80:83], v[192:195], v[104:107]
    s_waitcnt lgkmcnt(4)
    v_mfma_f32_16x16x32_bf16 v[104:107], v[84:87], v[196:199], v[104:107]
    s_waitcnt lgkmcnt(3)
    v_mfma_f32_16x16x32_bf16 v[104:107], v[88:91], v[176:179], v[104:107]
    s_waitcnt lgkmcnt(2)
    v_mfma_f32_16x16x32_bf16 v[104:107], v[92:95], v[180:183], v[104:107]
    s_waitcnt lgkmcnt(1)
    v_mfma_f32_16x16x32_bf16 v[104:107], v[96:99], v[184:187], v[104:107]
    s_lshl_b32 s4, s3, 10
    s_add_u32 m0, s4, 16384
    s_add_u32 s5, s74, 524288
    buffer_load_dwordx4 v222, s[68:71], s5 offen nt lds
    s_waitcnt lgkmcnt(0)
    v_mfma_f32_16x16x32_bf16 v[104:107], v[100:103], v[188:191], v[104:107]
    s_lshl_b32 s4, s3, 10
    s_add_u32 m0, s4, 24576
    s_add_u32 s5, s74, 786432
    buffer_load_dwordx4 v222, s[68:71], s5 offen nt lds
L_A3c:
    s_nop 3
    v_max3_f32 v108, v104, v105, v106
    v_max_f32 v108, v108, v107
    v_mov_b32 v4, v108
    s_nop 1
    v_permlane16_swap_b32 v108, v4
    v_max_f32 v108, v108, v4
    v_mov_b32 v4, v108
    s_nop 1
    v_permlane32_swap_b32 v108, v4
    v_max_f32 v108, v108, v4
    ds_write_b32 v217, v108
    s_waitcnt lgkmcnt(0)
    s_barrier
    ds_read_b128 v[40:43], v218
    ds_read_b128 v[44:47], v218 offset:16
    s_waitcnt lgkmcnt(1)
    v_max3_f32 v40, v40, v41, v42
    s_waitcnt lgkmcnt(0)
    v_max3_f32 v44, v44, v45, v46
    v_max3_f32 v40, v40, v43, v47
    v_max_f32 v40, v40, v44
    v_mul_f32 v100, s88, v40
    v_fma_f32 v104, v104, s88, -v100
    v_fma_f32 v105, v105, s88, -v100
    v_fma_f32 v106, v106, s88, -v100
    v_fma_f32 v107, v107, s88, -v100
    v_exp_f32 v104, v104
    v_exp_f32 v105, v105
    v_exp_f32 v106, v106
    v_exp_f32 v107, v107
    v_cvt_pk_bf16_f32 v40, v104, v106
    v_cvt_pk_bf16_f32 v41, v105, v107
    ds_write2_b32 v216, v40, v41 offset1:2
    v_mov_b32 v102, s76
    v_mov_b32 v103, s76
    s_waitcnt lgkmcnt(0)
    s_barrier
    ds_read_b128 v[40:43], v219 offset:0
    ds_read_b128 v[44:47], v219 offset:64
    ds_read_b128 v[48:51], v219 offset:128
    ds_read_b128 v[52:55], v219 offset:192
    s_cmp_eq_u32 s3, 3
    s_cbranch_scc0 L_A3n
    s_waitcnt lgkmcnt(3)
    v_mfma_f32_16x16x32_bf16 v[104:107], v[28:31], v[40:43], 0
    s_waitcnt lgkmcnt(2)
    v_mfma_f32_16x16x32_bf16 v[104:107], v[28:31], v[44:47], v[104:107]
    s_waitcnt lgkmcnt(1)
    v_mfma_f32_16x16x32_bf16 v[104:107], v[28:31], v[48:51], v[104:107]
    s_waitcnt lgkmcnt(0)
    v_mfma_f32_16x16x32_bf16 v[104:107], v[28:31], v[52:55], v[104:107]
    v_mfma_f32_16x16x32_bf16 v[56:59], v[112:115], v[40:43], 0
    v_mfma_f32_16x16x32_bf16 v[60:63], v[116:119], v[40:43], 0
    v_mfma_f32_16x16x32_bf16 v[64:67], v[120:123], v[40:43], 0
    v_mfma_f32_16x16x32_bf16 v[68:71], v[124:127], v[40:43], 0
    v_mfma_f32_16x16x32_bf16 v[56:59], v[128:131], v[44:47], v[56:59]
    v_mfma_f32_16x16x32_bf16 v[60:63], v[132:135], v[44:47], v[60:63]
    v_mfma_f32_16x16x32_bf16 v[64:67], v[136:139], v[44:47], v[64:67]
    v_mfma_f32_16x16x32_bf16 v[68:71], v[140:143], v[44:47], v[68:71]
    v_mov_b32 v101, v104
    buffer_store_dwordx4 v[100:103], v221, s[44:47], 0 offen sc1
    s_branch L_A3p
L_A3n:
    s_waitcnt lgkmcnt(3)
    v_mfma_f32_16x16x32_bf16 v[56:59], v[112:115], v[40:43], 0
    v_mfma_f32_16x16x32_bf16 v[60:63], v[116:119], v[40:43], 0
    v_mfma_f32_16x16x32_bf16 v[64:67], v[120:123], v[40:43], 0
    v_mfma_f32_16x16x32_bf16 v[68:71], v[124:127], v[40:43], 0
    s_waitcnt lgkmcnt(2)
    v_mfma_f32_16x16x32_bf16 v[56:59], v[128:131], v[44:47], v[56:59]
    v_mfma_f32_16x16x32_bf16 v[60:63], v[132:135], v[44:47], v[60:63]
    v_mfma_f32_16x16x32_bf16 v[64:67], v[136:139], v[44:47], v[64:67]
    v_mfma_f32_16x16x32_bf16 v[68:71], v[140:143], v[44:47], v[68:71]
L_A3p:
    s_waitcnt lgkmcnt(1)
    v_mfma_f32_16x16x32_bf16 v[56:59], v[144:147], v[48:51], v[56:59]
    v_mfma_f32_16x16x32_bf16 v[60:63], v[148:151], v[48:51], v[60:63]
    v_mfma_f32_16x16x32_bf16 v[64:67], v[152:155], v[48:51], v[64:67]
    v_mfma_f32_16x16x32_bf16 v[68:71], v[156:159], v[48:51], v[68:71]
    s_waitcnt lgkmcnt(0)
    v_mfma_f32_16x16x32_bf16 v[56:59], v[160:163], v[52:55], v[56:59]
    v_mfma_f32_16x16x32_bf16 v[60:63], v[164:167], v[52:55], v[60:63]
    v_mfma_f32_16x16x32_bf16 v[64:67], v[168:171], v[52:55], v[64:67]
    v_mfma_f32_16x16x32_bf16 v[68:71], v[172:175], v[52:55], v[68:71]
    s_mov_b32 s9, 0x80000
    s_nop 3
    v_add_u32 v56, 0x10000, v56
    v_add_u32 v57, 0x10000, v57
    v_add_u32 v58, 0x10000, v58
    v_add_u32 v59, 0x10000, v59
    v_add_u32 v60, 0x10000, v60
    v_add_u32 v61, 0x10000, v61
    v_add_u32 v62, 0x10000, v62
    v_add_u32 v63, 0x10000, v63
    v_perm_b32 v72, v57, v56, v253
    v_perm_b32 v73, v59, v58, v253
    v_perm_b32 v74, v61, v60, v253
    v_perm_b32 v75, v63, v62, v253
    v_bfi_b32 v72, v11, s78, v72
    v_bfi_b32 v73, v11, s78, v73
    v_bfi_b32 v74, v11, s78, v74
    v_bfi_b32 v75, v11, s78, v75
    ds_write_b128 v247, v[72:75]
    v_add_u32 v64, 0x10000, v64
    v_add_u32 v65, 0x10000, v65
    v_add_u32 v66, 0x10000, v66
    v_add_u32 v67, 0x10000, v67
    v_add_u32 v68, 0x10000, v68
    v_add_u32 v69, 0x10000, v69
    v_add_u32 v70, 0x10000, v70
    v_add_u32 v71, 0x10000, v71
    v_perm_b32 v76, v65, v64, v253
    v_perm_b32 v77, v67, v66, v253
    v_perm_b32 v78, v69, v68, v253
    v_perm_b32 v79, v71, v70, v253
    v_bfi_b32 v76, v11, s78, v76
    v_bfi_b32 v77, v11, s78, v77
    v_bfi_b32 v78, v11, s78, v78
    v_bfi_b32 v79, v11, s78, v79
    ds_write_b128 v248, v[76:79]
    s_waitcnt lgkmcnt(0)
    ds_read_b128 v[80:83], v249
    ds_read_b128 v[84:87], v249 offset:1024
    s_waitcnt lgkmcnt(1)
    buffer_store_dwordx4 v[80:83], v220, s[44:47], 0 offen sc1
    s_waitcnt lgkmcnt(0)
    buffer_store_dwordx4 v[84:87], v220, s[44:47], s9 offen sc1
    s_waitcnt vmcnt(3)
    s_cmp_eq_u32 s3, 3
    s_cbranch_scc1 L_A3o
    s_waitcnt vmcnt(2)
L_A3o:
    s_barrier
    s_lshl_b32 s10, s3, 11
    s_add_u32 s10, s10, 131072
    ds_read_b64_tr_b16 v[112:113], v228 offset:0
    ds_read_b64_tr_b16 v[114:115], v228 offset:4096
    ds_read_b64_tr_b16 v[116:117], v229 offset:0
    ds_read_b64_tr_b16 v[118:119], v229 offset:4096
    ds_read_b64_tr_b16 v[120:121], v230 offset:0
    ds_read_b64_tr_b16 v[122:123], v230 offset:4096
    ds_read_b64_tr_b16 v[124:125], v231 offset:0
    ds_read_b64_tr_b16 v[126:127], v231 offset:4096
    ds_read_b64_tr_b16 v[128:129], v232 offset:0
    ds_read_b64_tr_b16 v[130:131], v232 offset:4096
    ds_read_b64_tr_b16 v[132:133], v233 offset:0
    ds_read_b64_tr_b16 v[134:135], v233 offset:4096
    ds_read_b64_tr_b16 v[136:137], v234 offset:0
    ds_read_b64_tr_b16 v[138:139], v234 offset:4096
    ds_read_b64_tr_b16 v[140:141], v235 offset:0
    ds_read_b64_tr_b16 v[142:143], v235 offset:4096
    ds_read_b64_tr_b16 v[144:145], v228 offset:8192
    ds_read_b64_tr_b16 v[146:147], v228 offset:12288
    ds_read_b64_tr_b16 v[148:149], v229 offset:8192
    ds_read_b64_tr_b16 v[150:151], v229 offset:12288
    ds_read_b64_tr_b16 v[152:153], v230 offset:8192
    ds_read_b64_tr_b16 v[154:155], v230 offset:12288
    ds_read_b64_tr_b16 v[156:157], v231 offset:8192
    ds_read_b64_tr_b16 v[158:159], v231 offset:12288
    ds_read_b64_tr_b16 v[160:161], v232 offset:8192
    ds_read_b64_tr_b16 v[162:163], v232 offset:12288
    ds_read_b64_tr_b16 v[164:165], v233 offset:8192
    ds_read_b64_tr_b16 v[166:167], v233 offset:12288
    ds_read_b64_tr_b16 v[168:169], v234 offset:8192
    ds_read_b64_tr_b16 v[170:171], v234 offset:12288
    ds_read_b64_tr_b16 v[172:173], v235 offset:8192
    ds_read_b64_tr_b16 v[174:175], v235 offset:12288
    s_cmp_eq_u32 s3, 1
    s_cbranch_scc0 L_cpt
    buffer_load_dwordx4 v[12:15], v241, s[44:47], 0 offen sc1
    buffer_load_dwordx4 v[16:19], v241, s[44:47], 0 offen offset:1024 sc1
L_cpt:
    s_cmp_eq_u32 s3, 4
    s_cbranch_scc0 L_fpt
    s_cmp_lt_u32 s86, 36
    s_cbranch_scc0 L_fpt
    v_lshlrev_b32 v14, 4, v1
    s_lshl_b32 s4, s86, 13
    s_add_u32 s4, s4, 5242880
    buffer_load_dwordx4 v[176:179], v14, s[44:47], s4 offen offset:0 sc1
    buffer_load_dwordx4 v[180:183], v14, s[44:47], s4 offen offset:1024 sc1
    buffer_load_dwordx4 v[184:187], v14, s[44:47], s4 offen offset:2048 sc1
    buffer_load_dwordx4 v[188:191], v14, s[44:47], s4 offen offset:3072 sc1
    s_add_u32 s4, s4, 4096
    buffer_load_dwordx4 v[192:195], v14, s[44:47], s4 offen offset:0 sc1
    buffer_load_dwordx4 v[196:199], v14, s[44:47], s4 offen offset:1024 sc1
    buffer_load_dwordx4 v[200:203], v14, s[44:47], s4 offen offset:2048 sc1
    buffer_load_dwordx4 v[204:207], v14, s[44:47], s4 offen offset:3072 sc1
L_fpt:
    s_cmp_eq_u32 s3, 0
    s_cbranch_scc0 L_A4n
    s_and_b32 s4, s2, 7
    s_lshl_b32 s4, s4, 3
    s_lshl_b64 s[6:7], 0xff, s4
    s_andn2_b64 exec, -1, s[6:7]
    s_mov_b32 s87, 262144
Lp_58:
    buffer_load_dwordx4 v[48:51], v237, s[44:47], 0 offen sc1
    s_waitcnt vmcnt(0)
    v_bitop3_b32 v36, v50, v51, s76 bitop3:0x7e
    v_cmp_ne_u32 vcc, 0, v36
    s_cbranch_vccz Ld_59
    s_sub_u32 s87, s87, 1
    s_cbranch_scc0 Lp_58
Ld_59:
L_A4n:
    s_barrier
    s_cmp_eq_u32 s3, 0
    s_cbranch_scc0 L_A4l
    s_mov_b64 exec, s[6:7]
    buffer_load_dwordx4 v[48:51], v237, s[44:47], 0 offen sc1
    s_mov_b64 exec, -1
    s_mov_b32 m0, s10
    s_nop 0
    buffer_load_dwordx4 v236, s[44:47], 0 offen sc1 lds
    buffer_load_dwordx4 v236, s[44:47], 0 offen offset:1024 sc1 lds
    s_barrier
    s_waitcnt vmcnt(2)
    v_bitop3_b32 v36, v50, v51, s76 bitop3:0x7e
    v_cmp_ne_u32 vcc, 0, v36
    s_cbranch_vccz L_A4k
    s_mov_b32 s87, 262144
Lp_61:
    buffer_load_dwordx4 v[48:51], v237, s[44:47], 0 offen sc1
    s_waitcnt vmcnt(0)
    v_bitop3_b32 v36, v50, v51, s76 bitop3:0x7e
    v_cmp_ne_u32 vcc, 0, v36
    s_cbranch_vccz Ld_62
    s_sub_u32 s87, s87, 1
    s_cbranch_scc0 Lp_61
Ld_62:
L_A4k:
    v_mov_b32 v53, v48
    s_nop 1
    v_max_f32_dpp v53, v53, v53 row_ror:8 row_mask:0xf bank_mask:0xf
    s_nop 1
    v_max_f32_dpp v53, v53, v53 row_ror:4 row_mask:0xf bank_mask:0xf
    s_nop 1
    v_max_f32_dpp v53, v53, v53 row_ror:2 row_mask:0xf bank_mask:0xf
    s_nop 1
    v_max_f32_dpp v53, v53, v53 row_ror:1 row_mask:0xf bank_mask:0xf
    v_mov_b32 v54, v53
    s_nop 1
    v_permlane16_swap_b32 v53, v54
    v_max_f32 v53, v53, v54
    v_mov_b32 v54, v53
    s_nop 1
    v_permlane32_swap_b32 v53, v54
    v_max_f32 v53, v53, v54
    v_sub_f32 v52, v48, v53
    v_exp_f32 v52, v52
    s_nop 0
    v_mul_f32 v53, v52, v49
    s_nop 1
    v_add_f32_dpp v53, v53, v53 row_ror:8 row_mask:0xf bank_mask:0xf
    s_nop 1
    v_add_f32_dpp v53, v53, v53 row_ror:4 row_mask:0xf bank_mask:0xf
    s_nop 1
    v_add_f32_dpp v53, v53, v53 row_ror:2 row_mask:0xf bank_mask:0xf
    s_nop 1
    v_add_f32_dpp v53, v53, v53 row_ror:1 row_mask:0xf bank_mask:0xf
    v_mov_b32 v54, v53
    s_nop 1
    v_permlane16_swap_b32 v53, v54
    v_add_f32 v53, v53, v54
    v_mov_b32 v54, v53
    s_nop 1
    v_permlane32_swap_b32 v53, v54
    v_add_f32 v53, v53, v54
    v_rcp_f32 v53, v53
    s_nop 0
    v_mul_f32 v52, v52, v53
    ds_write_b32 v245, v52
    s_branch L_A4m
L_A4l:
    s_mov_b32 m0, s10
    s_nop 0
    buffer_load_dwordx4 v236, s[44:47], 0 offen sc1 lds
    buffer_load_dwordx4 v236, s[44:47], 0 offen offset:1024 sc1 lds
    s_barrier
    s_cmp_eq_u32 s3, 0
    s_cbranch_scc1 Lwo_64
    s_lshl_b32 s4, s3, 10
    s_add_u32 m0, s4, 31744
    s_nop 0
    buffer_load_dwordx4 v223, s[56:59], s8 offen nt lds
    s_add_u32 m0, s4, 38912
    s_nop 0
    buffer_load_dwordx4 v224, s[56:59], s8 offen nt lds
    s_add_u32 m0, s4, 46080
    s_nop 0
    buffer_load_dwordx4 v225, s[56:59], s8 offen nt lds
    s_add_u32 m0, s4, 53248
    s_nop 0
    buffer_load_dwordx4 v226, s[56:59], s8 offen nt lds
    s_add_u32 m0, s4, 60416
    s_nop 0
    buffer_load_dwordx4 v227, s[56:59], s8 offen nt lds
    s_cmp_eq_u32 s3, 1
    s_cbranch_scc0 Lwo_64
    s_add_u32 m0, s4, 67584
    s_nop 0
    buffer_load_dwordx4 v246, s[56:59], s8 offen nt lds
Lwo_64:
    s_waitcnt vmcnt(6)
    s_cmp_eq_u32 s3, 1
    s_cbranch_scc1 L_A4p
    s_waitcnt vmcnt(5)
L_A4p:
    ds_read_b128 v[40:43], v247
    ds_read_b128 v[44:47], v248
    s_waitcnt lgkmcnt(0)
    v_bitop3_b32 v32, v40, v41, s78 bitop3:0x7e
    v_bitop3_b32 v33, v42, v43, s78 bitop3:0x7e
    v_bitop3_b32 v34, v44, v45, s78 bitop3:0x7e
    v_bitop3_b32 v35, v46, v47, s78 bitop3:0x7e
    v_or3_b32 v32, v32, v33, v34
    v_or_b32 v32, v32, v35
    v_and_b32 v32, v11, v32
    v_cmp_ne_u32 vcc, 0, v32
    s_cbranch_vccz L_A4q
    s_mov_b32 s87, 262144
Lp_65:
    s_mov_b32 m0, s10
    s_nop 0
    buffer_load_dwordx4 v236, s[44:47], 0 offen sc1 lds
    buffer_load_dwordx4 v236, s[44:47], 0 offen offset:1024 sc1 lds
    s_waitcnt vmcnt(0)
    ds_read_b128 v[40:43], v247
    ds_read_b128 v[44:47], v248
    s_waitcnt lgkmcnt(0)
    v_bitop3_b32 v32, v40, v41, s78 bitop3:0x7e
    v_bitop3_b32 v33, v42, v43, s78 bitop3:0x7e
    v_bitop3_b32 v34, v44, v45, s78 bitop3:0x7e
    v_bitop3_b32 v35, v46, v47, s78 bitop3:0x7e
    v_or3_b32 v32, v32, v33, v34
    v_or_b32 v32, v32, v35
    v_and_b32 v32, v11, v32
    v_cmp_ne_u32 vcc, 0, v32
    s_cbranch_vccz Ld_66
    s_sub_u32 s87, s87, 1
    s_cbranch_scc0 Lp_65
Ld_66:
    s_branch L_A4q
L_A4m:
    s_mov_b32 s87, 262144
    s_branch Lq_70
Lp_68:
    s_mov_b32 m0, s10
    s_nop 0
    buffer_load_dwordx4 v236, s[44:47], 0 offen sc1 lds
    buffer_load_dwordx4 v236, s[44:47], 0 offen offset:1024 sc1 lds
Lq_70:
    s_waitcnt vmcnt(0)
    ds_read_b128 v[40:43], v247
    ds_read_b128 v[44:47], v248
    s_waitcnt lgkmcnt(0)
    v_bitop3_b32 v32, v40, v41, s78 bitop3:0x7e
    v_bitop3_b32 v33, v42, v43, s78 bitop3:0x7e
    v_bitop3_b32 v34, v44, v45, s78 bitop3:0x7e
    v_bitop3_b32 v35, v46, v47, s78 bitop3:0x7e
    v_or3_b32 v32, v32, v33, v34
    v_or_b32 v32, v32, v35
    v_and_b32 v32, v11, v32
    v_cmp_ne_u32 vcc, 0, v32
    s_cbranch_vccz Ld_69
    s_sub_u32 s87, s87, 1
    s_cbranch_scc0 Lp_68
Ld_69:
L_A4q:
    v_bfi_b32 v40, v11, 0, v40
    v_bfi_b32 v41, v11, 0, v41
    v_bfi_b32 v42, v11, 0, v42
    v_bfi_b32 v43, v11, 0, v43
    v_bfi_b32 v44, v11, 0, v44
    v_bfi_b32 v45, v11, 0, v45
    v_bfi_b32 v46, v11, 0, v46
    v_bfi_b32 v47, v11, 0, v47
    s_waitcnt lgkmcnt(0)
    v_mfma_f32_16x16x32_bf16 v[56:59], v[40:43], v[112:115], 0
    v_mfma_f32_16x16x32_bf16 v[56:59], v[44:47], v[144:147], v[56:59]
    v_mfma_f32_16x16x32_bf16 v[60:63], v[40:43], v[116:119], 0
    v_mfma_f32_16x16x32_bf16 v[60:63], v[44:47], v[148:151], v[60:63]
    v_mfma_f32_16x16x32_bf16 v[64:67], v[40:43], v[120:123], 0
    v_mfma_f32_16x16x32_bf16 v[64:67], v[44:47], v[152:155], v[64:67]
    s_barrier
    ds_read_b128 v[52:55], v244
    v_mfma_f32_16x16x32_bf16 v[68:71], v[40:43], v[124:127], 0
    v_mfma_f32_16x16x32_bf16 v[68:71], v[44:47], v[156:159], v[68:71]
    v_mfma_f32_16x16x32_bf16 v[72:75], v[40:43], v[128:131], 0
    v_mfma_f32_16x16x32_bf16 v[72:75], v[44:47], v[160:163], v[72:75]
    s_waitcnt lgkmcnt(0)
    v_mul_f32 v88, v52, v56
    v_fmac_f32 v88, v53, v57
    v_fmac_f32 v88, v54, v58
    v_fmac_f32 v88, v55, v59
    v_mul_f32 v89, v52, v60
    v_fmac_f32 v89, v53, v61
    v_fmac_f32 v89, v54, v62
    v_fmac_f32 v89, v55, v63
    v_mfma_f32_16x16x32_bf16 v[76:79], v[40:43], v[132:135], 0
    v_mfma_f32_16x16x32_bf16 v[76:79], v[44:47], v[164:167], v[76:79]
    v_mul_f32 v90, v52, v64
    v_fmac_f32 v90, v53, v65
    v_fmac_f32 v90, v54, v66
    v_fmac_f32 v90, v55, v67
    v_mul_f32 v91, v52, v68
    v_fmac_f32 v91, v53, v69
    v_fmac_f32 v91, v54, v70
    v_fmac_f32 v91, v55, v71
    v_mfma_f32_16x16x32_bf16 v[80:83], v[40:43], v[136:139], 0
    v_mfma_f32_16x16x32_bf16 v[80:83], v[44:47], v[168:171], v[80:83]
    v_mul_f32 v92, v52, v72
    v_fmac_f32 v92, v53, v73
    v_fmac_f32 v92, v54, v74
    v_fmac_f32 v92, v55, v75
    v_mul_f32 v93, v52, v76
    v_fmac_f32 v93, v53, v77
    v_fmac_f32 v93, v54, v78
    v_fmac_f32 v93, v55, v79
    v_mfma_f32_16x16x32_bf16 v[84:87], v[40:43], v[140:143], 0
    v_mfma_f32_16x16x32_bf16 v[84:87], v[44:47], v[172:175], v[84:87]
    v_mul_f32 v94, v52, v80
    v_fmac_f32 v94, v53, v81
    v_fmac_f32 v94, v54, v82
    v_fmac_f32 v94, v55, v83
    s_nop 3
    v_mul_f32 v95, v52, v84
    v_fmac_f32 v95, v53, v85
    v_fmac_f32 v95, v54, v86
    v_fmac_f32 v95, v55, v87
    v_permlane32_swap_b32 v88, v92
    v_permlane32_swap_b32 v89, v93
    v_permlane32_swap_b32 v90, v94
    v_permlane32_swap_b32 v91, v95
    v_add_f32 v88, v88, v92
    v_add_f32 v89, v89, v93
    v_add_f32 v90, v90, v94
    v_add_f32 v91, v91, v95
    s_nop 0
    v_permlane16_swap_b32 v88, v90
    v_permlane16_swap_b32 v89, v91
    v_add_f32 v88, v88, v90
    v_add_f32 v89, v89, v91
    v_add_u32 v88, 0x10000, v88
    v_add_u32 v89, 0x10000, v89
    v_perm_b32 v88, v89, v88, v253
    v_bfi_b32 v88, v11, s78, v88
    s_cmp_eq_u32 s85, 1
    s_cbranch_scc1 Ls_71
    buffer_store_dword v88, v238, s[44:47], 0 offen sc1
    s_branch Ls_72
Ls_71:
    buffer_store_dword v88, v238, s[44:47], 0 offen
Ls_72:
    s_lshl_b32 s9, s3, 10
    s_waitcnt vmcnt(1)
    s_barrier
    ds_read_b64_tr_b16 v[176:177], v239 offset:0
    ds_read_b64_tr_b16 v[178:179], v239 offset:2304
    ds_read_b64_tr_b16 v[180:181], v239 offset:256
    ds_read_b64_tr_b16 v[182:183], v239 offset:2560
    ds_read_b64_tr_b16 v[184:185], v239 offset:512
    ds_read_b64_tr_b16 v[186:187], v239 offset:2816
    ds_read_b64_tr_b16 v[188:189], v239 offset:768
    ds_read_b64_tr_b16 v[190:191], v239 offset:3072
    ds_read_b64_tr_b16 v[192:193], v240
    ds_read_b64_tr_b16 v[194:195], v240 offset:2304
    s_cmp_lt_u32 s3, 2
    s_cbranch_scc0 L_A5x
    s_mov_b32 s87, 262144
Lp_73:
    buffer_load_dwordx4 v[40:43], v241, s[44:47], s9 offen sc1
    s_waitcnt vmcnt(0)
    v_bitop3_b32 v32, v40, v41, s78 bitop3:0x7e
    v_bitop3_b32 v33, v42, v43, s78 bitop3:0x7e
    v_or_b32 v32, v32, v33
    v_and_b32 v32, v11, v32
    v_cmp_ne_u32 vcc, 0, v32
    s_cbranch_vccz Ld_74
    s_sub_u32 s87, s87, 1
    s_cbranch_scc0 Lp_73
Ld_74:
    v_bfi_b32 v40, v11, 0, v40
    v_bfi_b32 v41, v11, 0, v41
    v_bfi_b32 v42, v11, 0, v42
    v_bfi_b32 v43, v11, 0, v43
    ds_write_b128 v251, v[40:43]
L_A5x:
    s_waitcnt lgkmcnt(0)
    s_barrier
    ds_read_b128 v[40:43], v252
    ds_read_b128 v[44:47], v252 offset:1024
    s_waitcnt lgkmcnt(0)
    v_mfma_f32_16x16x32_bf16 v[56:59], v[40:43], v[176:179], 0
    v_mfma_f32_16x16x32_bf16 v[60:63], v[40:43], v[180:183], 0
    v_mfma_f32_16x16x32_bf16 v[64:67], v[40:43], v[184:187], 0
    v_mfma_f32_16x16x32_bf16 v[68:71], v[40:43], v[188:191], 0
    v_mfma_f32_16x16x32_bf16 v[72:75], v[40:43], v[192:195], 0
    v_mfma_f32_16x16x32_bf16 v[56:59], v[44:47], v[176:179], v[56:59]
    v_mfma_f32_16x16x32_bf16 v[60:63], v[44:47], v[180:183], v[60:63]
    v_mfma_f32_16x16x32_bf16 v[64:67], v[44:47], v[184:187], v[64:67]
    v_mfma_f32_16x16x32_bf16 v[68:71], v[44:47], v[188:191], v[68:71]
    v_mfma_f32_16x16x32_bf16 v[72:75], v[44:47], v[192:195], v[72:75]
    s_nop 3
    v_add_f32 v56, v56, v57
    v_add_f32 v58, v58, v59
    v_add_f32 v60, v60, v61
    v_add_f32 v62, v62, v63
    v_add_f32 v64, v64, v65
    v_add_f32 v66, v66, v67
    v_add_f32 v68, v68, v69
    v_add_f32 v70, v70, v71
    v_add_f32 v72, v72, v73
    v_add_f32 v74, v74, v75
    v_add_f32 v88, v56, v58
    v_add_f32 v89, v60, v62
    v_add_f32 v90, v64, v66
    v_add_f32 v91, v68, v70
    v_add_f32 v92, v72, v74
    v_permlane32_swap_b32 v88, v90
    v_permlane32_swap_b32 v89, v91
    v_mov_b32 v4, v92
    v_add_f32 v88, v88, v90
    v_add_f32 v89, v89, v91
    v_permlane32_swap_b32 v92, v4
    v_add_f32 v92, v92, v4
    v_permlane16_swap_b32 v88, v89
    v_mov_b32 v4, v92
    v_add_f32 v88, v88, v89
    v_bfi_b32 v88, v10, s76, v88
    buffer_store_dword v88, v242, s[44:47], 0 offen sc1
    v_permlane16_swap_b32 v92, v4
    v_add_f32 v92, v92, v4
    v_bfi_b32 v92, v10, s76, v92
    s_cmp_ge_u32 s3, 4
    s_cbranch_scc1 L_finA
    s_mov_b64 exec, 0xffff
    buffer_store_dword v92, v243, s[44:47], 0 offen sc1
    s_branch L_exit
L_finA:
    s_cmp_lt_u32 s86, 36
    s_cbranch_scc0 L_exit
    s_lshl_b32 s8, s86, 5
    s_add_u32 s8, s8, 0
    s_lshl_b32 s4, s86, 13
    s_and_b32 s5, s3, 3
    s_lshl_b32 s6, s5, 11
    s_add_u32 s4, s4, s6
    s_add_u32 s4, s4, 5242880
    v_lshlrev_b32 v22, 4, v1
    v_lshlrev_b32 v21, 3, v2
    v_lshl_add_u32 v21, v3, 1, v21
    s_lshl_b32 s5, s5, 2
    s_add_u32 s5, s5, 139264
    v_lshl_add_u32 v23, v1, 4, s5
    v_add_u32 v20, 139264, v22
    s_mov_b32 s72, s38
    s_mov_b32 s73, s39
    s_mov_b32 s74, 2304
    s_mov_b32 s75, 0x20000
    s_mov_b32 s87, 262144
Lp_76:
    buffer_load_dwordx4 v[40:43], v22, s[44:47], s4 offen offset:0 sc1
    buffer_load_dwordx4 v[44:47], v22, s[44:47], s4 offen offset:1024 sc1
    s_waitcnt vmcnt(0)
    v_bitop3_b32 v72, v40, v41, s76 bitop3:0x7e
    v_bitop3_b32 v73, v42, v43, s76 bitop3:0x7e
    v_bitop3_b32 v74, v44, v45, s76 bitop3:0x7e
    v_bitop3_b32 v75, v46, v47, s76 bitop3:0x7e
    v_or3_b32 v72, v72, v73, v74
    v_or_b32 v72, v72, v75
    v_and_b32 v72, v10, v72
    v_cmp_ne_u32 vcc, 0, v72
    s_cbranch_vccz Ld_77
    s_sub_u32 s87, s87, 1
    s_cbranch_scc0 Lp_76
Ld_77:
    v_bfi_b32 v40, v10, 0, v40
    v_bfi_b32 v41, v10, 0, v41
    v_bfi_b32 v42, v10, 0, v42
    v_bfi_b32 v43, v10, 0, v43
    v_bfi_b32 v44, v10, 0, v44
    v_bfi_b32 v45, v10, 0, v45
    v_bfi_b32 v46, v10, 0, v46
    v_bfi_b32 v47, v10, 0, v47
    v_add_f32 v40, v40, v44
    v_add_f32 v41, v41, v45
    v_add_f32 v42, v42, v46
    v_add_f32 v43, v43, v47
    s_nop 0
    v_permlane32_swap_b32 v40, v42
    v_permlane32_swap_b32 v41, v43
    v_add_f32 v40, v40, v42
    v_add_f32 v41, v41, v43
    s_nop 1
    v_permlane16_swap_b32 v40, v41
    v_add_f32 v40, v40, v41
    s_nop 1
    v_add_f32_dpp v40, v40, v40 row_ror:8 row_mask:0xf bank_mask:0xf
    s_nop 1
    v_add_f32_dpp v40, v40, v40 row_ror:4 row_mask:0xf bank_mask:0xf
    ds_write_b32 v23, v40
    s_waitcnt lgkmcnt(0)
    s_barrier
    s_cmp_eq_u32 s3, 4
    s_cbranch_scc0 L_exit
    ds_read_b128 v[40:43], v20
    s_waitcnt lgkmcnt(0)
    v_add_f32 v40, v40, v41
    v_add_f32 v42, v42, v43
    v_add_f32 v40, v40, v42
    v_cvt_pk_bf16_f32 v40, v40, v40
    s_mov_b32 exec_lo, 0xf000f
    s_mov_b32 exec_hi, 0xf000f
    buffer_store_short v40, v21, s[72:75], s8 offen
    s_cmp_eq_u32 s86, 0
    s_cbranch_scc0 L_exit
    s_mov_b64 exec, 1
    v_mov_b32 v41, s76
    v_mov_b32 v42, 0
    buffer_store_dword v41, v42, s[44:47], 0 offen offset:0 sc1
    s_branch L_exit
L_exit:
L_exit0:
    s_endpgm

.section .rodata,"a"
.p2align 6
.amdhsa_kernel concat_heads__compressed_kv_cla__sliding_block_cached__decode_kernel
  .amdhsa_next_free_vgpr 256
  .amdhsa_next_free_sgpr 102
  .amdhsa_accum_offset 256
  .amdhsa_group_segment_fixed_size 0
  .amdhsa_kernarg_size 112
  .amdhsa_user_sgpr_count 2
  .amdhsa_user_sgpr_kernarg_segment_ptr 1
  .amdhsa_system_sgpr_workgroup_id_x 1
.end_amdhsa_kernel
```
